```python
import torch

def _softmax(x, axis=-1):
    return torch.softmax(x, dim=axis)
def _gelu(x):
    return torch.nn.functional.gelu(x, approximate="tanh")
def _silu(x):
    return torch.nn.functional.silu(x)
def _sigmoid(x):
    return torch.sigmoid(x)
def _layernorm(x, axis=-1, eps=1e-5):
    m = x.mean(dim=axis, keepdim=True)
    v = x.var(dim=axis, keepdim=True, unbiased=False)
    return (x - m) / torch.sqrt(v + eps)
def _scatter_add(tgt, idx, src, axis=0):
    return tgt.clone().index_add_(axis, idx, src)
def _segment_sum(src, seg, n):
    out = torch.zeros((n,) + src.shape[1:], dtype=src.dtype)
    return out.index_add_(0, seg, src)
def _pad(x, pw):
    flat = tuple(v for pair in reversed(pw) for v in pair)
    return torch.nn.functional.pad(x, flat)

kernel_name = 'sequential_preLN__sliding_block_cached__glu_gated_glu__decode'

def setup_inputs():

    _w = (lambda a: (lambda t: t.to(torch.bfloat16) if t.is_floating_point() else t)(torch.as_tensor(a)))
    def _A_setup():
        B, Sq, D = 4, 1, 512
        Hq, Hkv, Sk, Dh = 32, 8, 8192, 128
        assert Hq % Hkv == 0, (Hq, Hkv)
        return {
            "x": _w((lambda *s: torch.randn(*s, dtype=torch.bfloat16) * 0.05)(B, Sq, D)),
            "k_cache": _w((lambda *s: torch.randn(*s, dtype=torch.bfloat16) * 3.2)(B, Hkv, Sk, Dh)),
            "v_cache": _w((lambda *s: torch.randn(*s, dtype=torch.bfloat16) * 0.4)(B, Hkv, Sk, Dh)),
            "wq": _w((lambda *s: torch.randn(*s, dtype=torch.bfloat16) * 3.2)(D, Hq * Dh) * (D ** -0.5)),
            "wo": _w((lambda *s: torch.randn(*s, dtype=torch.bfloat16) * 0.4)(Hq * Dh, D) * ((Hq * Dh) ** -0.5)),
        }
    _A_in = _A_setup()

    def _B_setup():
        B, S, D, F = 4, 1, 512, 1792
        return {
            "x": _w((lambda *s: torch.randn(*s, dtype=torch.bfloat16) * 0.05)(B, S, D)),
            "w_gate": _w((lambda *s: torch.randn(*s, dtype=torch.bfloat16) * 0.1)(D, F)),
            "w_up": _w((lambda *s: torch.randn(*s, dtype=torch.bfloat16) * 0.05)(D, F)),
            "w_down": _w((lambda *s: torch.randn(*s, dtype=torch.bfloat16) * 0.05)(F, D)),
        }
    _B_in = _B_setup()

    return {
        "A_x": _A_in["x"],
        "A_k_cache": _A_in["k_cache"],
        "A_v_cache": _A_in["v_cache"],
        "A_wq": _A_in["wq"],
        "A_wo": _A_in["wo"],
        "B_x": _B_in["x"],
        "B_w_gate": _B_in["w_gate"],
        "B_w_up": _B_in["w_up"],
        "B_w_down": _B_in["w_down"],
    }

def reference(A_x, A_k_cache, A_v_cache, A_wq, A_wo, B_x, B_w_gate, B_w_up, B_w_down):
    def _A_ref(x, k_cache, v_cache, wq, wo):
        B, Sq, D = x.shape
        Hq, Dh = 32, 128
        Hkv, Sk = k_cache.shape[1], k_cache.shape[2]
        W = min(4096, max(256, Sk // 4))
        rep = Hq // Hkv
        q = (lambda x, *d: x.permute(*d))((x @ wq).reshape(B, Sq, Hq, Dh), 0, 2, 1, 3)
        k = (lambda x, n, axis: torch.repeat_interleave(x, n, dim=axis))(k_cache[:, :, Sk - W:, :], rep, axis=1)
        v = (lambda x, n, axis: torch.repeat_interleave(x, n, dim=axis))(v_cache[:, :, Sk - W:, :], rep, axis=1)
        scores = torch.einsum("bhqd,bhkd->bhqk", q, k) * (Dh ** -0.5)
        p = _softmax(scores, axis=-1)
        o = torch.einsum("bhqk,bhkd->bhqd", p, v)
        return (lambda x, *d: x.permute(*d))(o, 0, 2, 1, 3).reshape(B, Sq, Hq * Dh) @ wo

    def _B_ref(x, w_gate, w_up, w_down):
        g = torch.einsum("bsd,df->bsf", x, w_gate)
        u = torch.einsum("bsd,df->bsf", x, w_up)
        h = _sigmoid(g) * u
        return torch.einsum("bsf,fd->bsd", h, w_down)

    x = A_x
    h = x + _A_ref(_layernorm(x, axis=-1), A_k_cache, A_v_cache, A_wq, A_wo)
    h2 = h + _B_ref(_layernorm(h, axis=-1), B_w_gate, B_w_up, B_w_down)
    return h2
```

```asm
; @launch grid=(256,1,1) block=(704,1,1) lds=156160
.amdgcn_target "amdgcn-amd-amdhsa--gfx950"
.text
.globl sequential_preLN__sliding_block_cached__glu_gated_glu__decode_kernel
.p2align 8
.type sequential_preLN__sliding_block_cached__glu_gated_glu__decode_kernel,@function
sequential_preLN__sliding_block_cached__glu_gated_glu__decode_kernel:
    s_load_dwordx16 s[4:19], s[0:1], 0
    s_load_dwordx8 s[20:27], s[0:1], 64
    s_cmp_ge_u32 s2, 256
    s_cbranch_scc1 L_end
    v_lshrrev_b32 v4, 6, v0
    v_and_b32 v1, 63, v0
    v_readfirstlane_b32 s32, v4
    s_and_b32 s28, s2, 7
    s_lshr_b32 s29, s2, 3
    v_lshlrev_b32 v5, 4, v1
    s_lshr_b32 s30, s29, 3
    s_and_b32 s37, s29, 3
    s_lshl_b32 s36, s30, 2
    s_add_u32 s31, s37, s36
    s_bfe_u32 s38, s29, 0x10002
    v_lshrrev_b32 v2, 4, v1
    v_and_b32 v3, 15, v1
    v_mov_b32 v6, 151424
    s_cmp_eq_u32 s32, 0
    s_cbranch_scc1 L_loader
    s_sub_u32 s32, s32, 1
    s_getpc_b64 s[56:57]
    s_min_u32 s39, s29, 13
    s_and_b32 s40, s32, 3
    s_cmp_eq_u32 s32, 2
    s_cselect_b32 s39, s39, s40
    s_lshl_b32 s39, s39, 10
    v_add_u32 v10, s39, v5
    s_lshr_b32 s40, s32, 2
    s_and_b32 s40, s40, s38
    s_waitcnt lgkmcnt(0)
    s_load_dword s34, s[26:27], 0
    s_cmp_eq_u32 s40, 0
    s_cbranch_scc1 L_nox
    global_load_dwordx4 v[16:19], v10, s[4:5]
L_nox:
    s_cmp_lg_u32 s32, 2
    s_cbranch_scc1 L_nopf
    global_load_dwordx4 v[128:131], v10, s[56:57]
L_nopf:
    s_barrier
    s_branch L_compute
L_loader:
    v_mov_b32 v8, 0
    v_lshl_add_u32 v9, v3, 2, v6
    ds_write_b32 v9, v8
    s_setprio 2
    s_lshl_b32 s39, s29, 17
    s_lshl_b32 s40, s28, 10
    s_add_u32 s39, s39, s40
    v_lshrrev_b32 v21, 3, v1
    v_and_b32 v22, 7, v1
    v_lshlrev_b32 v22, 7, v22
    v_lshl_add_u32 v23, v21, 13, v22
    v_add_u32 v24, 0x10000, v23
    v_lshlrev_b32 v7, 8, v2
    v_add_u32 v8, 0, v2
    v_xor_b32 v8, v8, v3
    v_lshl_add_u32 v10, v8, 4, v7
    v_add_u32 v8, 4, v2
    v_xor_b32 v8, v8, v3
    v_lshl_add_u32 v11, v8, 4, v7
    v_add_u32 v8, 8, v2
    v_xor_b32 v8, v8, v3
    v_lshl_add_u32 v12, v8, 4, v7
    v_add_u32 v8, 12, v2
    v_xor_b32 v8, v8, v3
    v_lshl_add_u32 v13, v8, 4, v7
    s_cmp_eq_u32 s38, 0
    s_mov_b32 s51, 57344
    s_cselect_b32 s51, 73728, s51
    s_mov_b32 s42, 1867776
    s_cselect_b32 s42, 1572864, s42
    s_cselect_b32 s43, 8, 2
    s_mul_i32 s37, s37, s51
    s_add_u32 s42, s42, s37
    s_lshl_b32 s36, s30, 24
    s_lshl_b32 s40, s28, 21
    s_add_u32 s36, s36, s40
    s_add_u32 s36, s36, s42
    s_mul_i32 s50, s30, 3
    s_add_u32 s50, s50, s28
    s_and_b32 s41, s29, 7
    s_lshl_b32 s41, s41, 1
    s_add_u32 s50, s50, s41
    s_and_b32 s50, s50, 15
    s_min_u32 s50, s50, 13
    s_lshl_b32 s50, s50, 12
    s_lshr_b32 s41, s51, 12
    s_mov_b32 m0, 0
    s_waitcnt lgkmcnt(0)
    s_add_u32 s14, s10, s39
    s_addc_u32 s15, s11, 0
    global_load_dword v16, v23, s[14:15]
    global_load_dword v17, v24, s[14:15]
    s_barrier
    s_add_u32 s6, s6, s36
    s_addc_u32 s7, s7, 0
    s_mov_b32 s3, s43
L_k0:
    s_add_u32 s52, s6, s50
    s_addc_u32 s53, s7, 0
    global_load_lds_dwordx4 v10, s[52:53] offset:0 nt
    global_load_lds_dwordx4 v11, s[52:53] offset:1024 nt
    global_load_lds_dwordx4 v12, s[52:53] offset:2048 nt
    global_load_lds_dwordx4 v13, s[52:53] offset:3072 nt
    s_add_u32 m0, m0, 4096
    s_add_u32 s50, s50, 4096
    s_cmp_eq_u32 s50, s51
    s_cselect_b32 s50, 0, s50
    s_sub_u32 s3, s3, 1
    s_cmp_lg_u32 s3, 0
    s_cbranch_scc1 L_k0
    s_add_u32 s8, s8, s36
    s_addc_u32 s9, s9, 0
    v_lshl_add_u32 v8, v2, 1, 0
    v_xor_b32 v8, v8, v3
    v_lshl_add_u32 v14, v8, 4, v7
    v_lshl_add_u32 v8, v2, 1, 8
    v_xor_b32 v8, v8, v3
    v_lshl_add_u32 v15, v8, 4, v7
    v_mov_b32 v8, 1
    s_cmp_eq_u32 s38, 0
    s_cbranch_scc1 L_ld_o
    v_lshrrev_b32 v21, 2, v1
    v_and_b32 v7, 3, v1
    v_lshlrev_b32 v7, 4, v7
    v_lshl_add_u32 v21, v21, 13, v7
    v_add_u32 v22, 130048, v21
    v_add_u32 v23, 260096, v21
    v_add_u32 v24, 390144, v21
    s_lshl_b32 s37, s28, 10
    s_lshl_b32 s40, s31, 6
    s_add_u32 s37, s37, s40
    s_add_u32 s10, s10, s37
    s_addc_u32 s11, s11, 0
    s_mov_b32 m0, 73728
    s_mov_b32 s3, 8
    s_waitcnt vmcnt(8)
L_wq_loop:
    global_load_lds_dwordx4 v21, s[10:11] offset:0
    global_load_lds_dwordx4 v22, s[10:11] offset:1024
    global_load_lds_dwordx4 v23, s[10:11] offset:2048
    global_load_lds_dwordx4 v24, s[10:11] offset:3072
    s_add_u32 m0, m0, 4096
    s_add_u32 s10, s10, 0x80000
    s_addc_u32 s11, s11, 0
    s_sub_u32 s3, s3, 1
    s_cmp_lg_u32 s3, 0
    s_cbranch_scc1 L_wq_loop
    s_mov_b32 m0, 8192
    s_mov_b32 s3, 6
L_k1:
    s_add_u32 s52, s6, s50
    s_addc_u32 s53, s7, 0
    global_load_lds_dwordx4 v10, s[52:53] offset:0 nt
    global_load_lds_dwordx4 v11, s[52:53] offset:1024 nt
    global_load_lds_dwordx4 v12, s[52:53] offset:2048 nt
    global_load_lds_dwordx4 v13, s[52:53] offset:3072 nt
    s_add_u32 m0, m0, 4096
    s_add_u32 s50, s50, 4096
    s_cmp_eq_u32 s50, s51
    s_cselect_b32 s50, 0, s50
    s_sub_u32 s3, s3, 1
    s_cmp_lg_u32 s3, 0
    s_cbranch_scc1 L_k1
    s_waitcnt vmcnt(24)
    ds_write_b32 v6, v8 offset:0
    s_mov_b32 s3, 1600000
L_wf_lq_1:
    ds_read_b32 v7, v6 offset:12
    s_waitcnt lgkmcnt(0)
    v_readfirstlane_b32 s39, v7
    s_nop 0
    s_cmp_ge_u32 s39, 2
    s_cbranch_scc1 L_wfd_lq_2
    s_sleep 1
    s_sub_u32 s3, s3, 1
    s_cbranch_scc0 L_wf_lq_1
L_wfd_lq_2:
    v_mov_b32 v20, -4
    s_mov_b32 s42, 6
    s_branch L_ld_k
L_ld_o:
    v_mov_b32 v20, -4
    s_mov_b32 s42, 10
L_ld_k:
    s_mov_b32 s3, s42
L_k2:
    s_add_u32 s52, s6, s50
    s_addc_u32 s53, s7, 0
    global_load_lds_dwordx4 v10, s[52:53] offset:0 nt
    global_load_lds_dwordx4 v11, s[52:53] offset:1024 nt
    global_load_lds_dwordx4 v12, s[52:53] offset:2048 nt
    global_load_lds_dwordx4 v13, s[52:53] offset:3072 nt
    s_add_u32 m0, m0, 4096
    s_add_u32 s50, s50, 4096
    s_cmp_eq_u32 s50, s51
    s_cselect_b32 s50, 0, s50
    s_waitcnt vmcnt(48)
    v_add_u32 v20, 1, v20
    ds_write_b32 v6, v20 offset:4
    s_sub_u32 s3, s3, 1
    s_cmp_lg_u32 s3, 0
    s_cbranch_scc1 L_k2
    s_mov_b32 m0, 73728
    s_mov_b32 s3, s41
L_v1:
    s_add_u32 s52, s8, s50
    s_addc_u32 s53, s9, 0
    global_load_lds_dwordx4 v14, s[52:53] offset:0 nt
    global_load_lds_dwordx4 v15, s[52:53] offset:1024 nt
    global_load_lds_dwordx4 v14, s[52:53] offset:2048 nt
    global_load_lds_dwordx4 v15, s[52:53] offset:3072 nt
    s_add_u32 m0, m0, 4096
    s_add_u32 s50, s50, 4096
    s_cmp_eq_u32 s50, s51
    s_cselect_b32 s50, 0, s50
    s_waitcnt vmcnt(48)
    v_add_u32 v20, 1, v20
    ds_write_b32 v6, v20 offset:4
    s_sub_u32 s3, s3, 1
    s_cmp_lg_u32 s3, 0
    s_cbranch_scc1 L_v1
    s_cmp_lg_u32 s38, 0
    s_cbranch_scc1 L_ld_q
    s_lshl_b32 s37, s28, 19
    s_lshl_b32 s40, s31, 15
    s_add_u32 s37, s37, s40
    s_add_u32 s14, s12, s37
    s_addc_u32 s15, s13, 0
    s_mov_b32 s54, s50
    s_mov_b32 s55, s51
    s_and_b32 s50, s50, 0x7000
    s_mov_b32 s51, 0x8000
    s_mov_b32 s3, 8
L_pfo:
    s_add_u32 s52, s14, s50
    s_addc_u32 s53, s15, 0
    global_load_dwordx4 v[16:19], v5, s[52:53] offset:0
    global_load_dwordx4 v[16:19], v5, s[52:53] offset:1024
    global_load_dwordx4 v[16:19], v5, s[52:53] offset:2048
    global_load_dwordx4 v[16:19], v5, s[52:53] offset:3072
    s_add_u32 m0, m0, 4096
    s_add_u32 s50, s50, 4096
    s_cmp_eq_u32 s50, s51
    s_cselect_b32 s50, 0, s50
    s_waitcnt vmcnt(48)
    v_add_u32 v20, 1, v20
    ds_write_b32 v6, v20 offset:4
    s_sub_u32 s3, s3, 1
    s_cmp_lg_u32 s3, 0
    s_cbranch_scc1 L_pfo
    s_mov_b32 s50, s54
    s_mov_b32 s51, s55
    s_waitcnt vmcnt(44)
    v_add_u32 v20, 1, v20
    ds_write_b32 v6, v20 offset:4
    s_waitcnt vmcnt(40)
    v_add_u32 v20, 1, v20
    ds_write_b32 v6, v20 offset:4
    s_waitcnt vmcnt(36)
    v_add_u32 v20, 1, v20
    ds_write_b32 v6, v20 offset:4
    s_waitcnt vmcnt(32)
    v_add_u32 v20, 1, v20
    ds_write_b32 v6, v20 offset:4
    s_waitcnt vmcnt(32)
    ds_write_b32 v6, v8 offset:8
    s_branch L_fin
L_ld_q:
    s_waitcnt vmcnt(44)
    v_add_u32 v20, 1, v20
    ds_write_b32 v6, v20 offset:4
    s_waitcnt vmcnt(40)
    v_add_u32 v20, 1, v20
    ds_write_b32 v6, v20 offset:4
    s_waitcnt vmcnt(36)
    v_add_u32 v20, 1, v20
    ds_write_b32 v6, v20 offset:4
    s_waitcnt vmcnt(32)
    v_add_u32 v20, 1, v20
    ds_write_b32 v6, v20 offset:4
    s_waitcnt vmcnt(28)
    v_add_u32 v20, 1, v20
    ds_write_b32 v6, v20 offset:4
    s_waitcnt vmcnt(24)
    v_add_u32 v20, 1, v20
    ds_write_b32 v6, v20 offset:4
    s_waitcnt vmcnt(20)
    v_add_u32 v20, 1, v20
    ds_write_b32 v6, v20 offset:4
    s_waitcnt vmcnt(16)
    v_add_u32 v20, 1, v20
    ds_write_b32 v6, v20 offset:4
    s_waitcnt vmcnt(0)
    s_barrier
    s_branch L_fin
L_compute:
    v_mov_b32 v8, 1
    v_and_b32 v9, 3, v3
    v_lshrrev_b32 v13, 2, v3
    s_cmp_eq_u32 s40, 0
    s_cbranch_scc1 L_noln
    v_add_u32 v12, 65536, v10
    s_and_b32 s39, s32, 3
    s_mul_i32 s39, s39, 1040
    s_add_u32 s39, s39, 139264
    v_add_u32 v11, s39, v5
    s_waitcnt vmcnt(0)
    ds_write_b128 v12, v[16:19]
    v_lshlrev_b32 v20, 16, v16
    v_and_b32 v21, 0xffff0000, v16
    v_lshlrev_b32 v22, 16, v17
    v_and_b32 v23, 0xffff0000, v17
    v_lshlrev_b32 v24, 16, v18
    v_and_b32 v25, 0xffff0000, v18
    v_lshlrev_b32 v26, 16, v19
    v_and_b32 v27, 0xffff0000, v19
    v_add_f32 v28, v20, v21
    v_add_f32 v29, v22, v23
    v_add_f32 v30, v24, v25
    v_add_f32 v31, v26, v27
    v_add_f32 v28, v28, v29
    v_add_f32 v30, v30, v31
    v_add_f32 v28, v28, v30
    s_nop 1
    v_add_f32_dpp v28, v28, v28 quad_perm:[1,0,3,2] row_mask:0xf bank_mask:0xf
    s_nop 1
    v_add_f32_dpp v28, v28, v28 quad_perm:[2,3,0,1] row_mask:0xf bank_mask:0xf
    s_nop 1
    v_add_f32_dpp v28, v28, v28 row_half_mirror row_mask:0xf bank_mask:0xf
    s_nop 1
    v_add_f32_dpp v28, v28, v28 row_mirror row_mask:0xf bank_mask:0xf
    v_mov_b32 v29, v28
    s_nop 1
    v_permlane16_swap_b32 v28, v29
    v_add_f32 v28, v28, v29
    v_mov_b32 v29, v28
    s_nop 1
    v_permlane32_swap_b32 v28, v29
    v_add_f32 v28, v28, v29
    v_mul_f32 v28, 0x3b000000, v28
    v_sub_f32 v30, v20, v28
    v_mul_f32 v29, v30, v30
    v_sub_f32 v30, v21, v28
    v_fmac_f32 v29, v30, v30
    v_sub_f32 v30, v22, v28
    v_fmac_f32 v29, v30, v30
    v_sub_f32 v30, v23, v28
    v_fmac_f32 v29, v30, v30
    v_sub_f32 v30, v24, v28
    v_fmac_f32 v29, v30, v30
    v_sub_f32 v30, v25, v28
    v_fmac_f32 v29, v30, v30
    v_sub_f32 v30, v26, v28
    v_fmac_f32 v29, v30, v30
    v_sub_f32 v30, v27, v28
    v_fmac_f32 v29, v30, v30
    s_nop 1
    v_add_f32_dpp v29, v29, v29 quad_perm:[1,0,3,2] row_mask:0xf bank_mask:0xf
    s_nop 1
    v_add_f32_dpp v29, v29, v29 quad_perm:[2,3,0,1] row_mask:0xf bank_mask:0xf
    s_nop 1
    v_add_f32_dpp v29, v29, v29 row_half_mirror row_mask:0xf bank_mask:0xf
    s_nop 1
    v_add_f32_dpp v29, v29, v29 row_mirror row_mask:0xf bank_mask:0xf
    v_mov_b32 v30, v29
    s_nop 1
    v_permlane16_swap_b32 v29, v30
    v_add_f32 v29, v29, v30
    v_mov_b32 v30, v29
    s_nop 1
    v_permlane32_swap_b32 v29, v30
    v_add_f32 v29, v29, v30
    v_mul_f32 v29, 0x3b000000, v29
    v_cvt_pk_bf16_f32 v28, v28, v28
    v_and_b32 v28, 0xffff0000, v28
    v_cvt_pk_bf16_f32 v29, v29, v29
    v_and_b32 v29, 0xffff0000, v29
    v_add_f32 v29, 0x3727c5ac, v29
    v_cvt_pk_bf16_f32 v29, v29, v29
    v_and_b32 v29, 0xffff0000, v29
    v_sqrt_f32 v29, v29
    s_nop 0
    v_cvt_pk_bf16_f32 v29, v29, v29
    v_and_b32 v29, 0xffff0000, v29
    v_rcp_f32 v29, v29
    v_sub_f32 v20, v20, v28
    v_sub_f32 v21, v21, v28
    v_sub_f32 v22, v22, v28
    v_sub_f32 v23, v23, v28
    v_sub_f32 v24, v24, v28
    v_sub_f32 v25, v25, v28
    v_sub_f32 v26, v26, v28
    v_sub_f32 v27, v27, v28
    v_cvt_pk_bf16_f32 v32, v20, v21
    v_cvt_pk_bf16_f32 v33, v22, v23
    v_cvt_pk_bf16_f32 v34, v24, v25
    v_cvt_pk_bf16_f32 v35, v26, v27
    v_lshlrev_b32 v20, 16, v32
    v_and_b32 v21, 0xffff0000, v32
    v_lshlrev_b32 v22, 16, v33
    v_and_b32 v23, 0xffff0000, v33
    v_lshlrev_b32 v24, 16, v34
    v_and_b32 v25, 0xffff0000, v34
    v_lshlrev_b32 v26, 16, v35
    v_and_b32 v27, 0xffff0000, v35
    v_mul_f32 v20, v20, v29
    v_mul_f32 v21, v21, v29
    v_mul_f32 v22, v22, v29
    v_mul_f32 v23, v23, v29
    v_mul_f32 v24, v24, v29
    v_mul_f32 v25, v25, v29
    v_mul_f32 v26, v26, v29
    v_mul_f32 v27, v27, v29
    v_cvt_pk_bf16_f32 v32, v20, v21
    v_cvt_pk_bf16_f32 v33, v22, v23
    v_cvt_pk_bf16_f32 v34, v24, v25
    v_cvt_pk_bf16_f32 v35, v26, v27
    ds_write_b128 v11, v[32:35]
    s_mov_b64 exec, 1
    ds_add_u32 v6, v8 offset:32
    s_mov_b64 exec, -1
L_noln:
    s_getreg_b32 s35, hwreg(HW_REG_XCC_ID, 0, 4)
    s_cmp_eq_u32 s38, 0
    s_cbranch_scc1 L_p_done
    s_cmp_ge_u32 s32, 2
    s_cbranch_scc1 L_p_done
    v_mov_b32 v16, -1
    v_mov_b32 v17, -1
    v_mov_b32 v18, -1
    v_mov_b32 v19, -1
    s_lshl_b32 s42, s31, 1
    s_add_u32 s42, s42, s32
    s_lshl_b32 s39, s28, 15
    s_lshl_b32 s40, s42, 10
    s_add_u32 s39, s39, s40
    s_add_u32 s39, s39, 131072
    v_add_u32 v11, s39, v5
    global_store_dwordx4 v11, v[16:19], s[26:27] sc1
    s_lshl_b32 s39, s28, 13
    s_lshl_b32 s40, s42, 8
    s_add_u32 s39, s39, s40
    s_add_u32 s39, s39, 393216
    s_lshl_b32 s41, s31, 12
    s_lshl_b32 s40, s28, 9
    s_add_u32 s41, s41, s40
    s_lshl_b32 s40, s32, 8
    s_add_u32 s41, s41, s40
    s_add_u32 s41, s41, 786432
    s_sub_u32 s43, s41, 262144
    v_mov_b32 v11, s43
    v_mov_b32 v12, s41
    v_cmp_eq_u32 vcc, 1, v2
    s_nop 1
    v_cndmask_b32 v11, v11, v12, vcc
    v_mov_b32 v12, s39
    v_cmp_eq_u32 vcc, 0, v2
    s_nop 1
    v_cndmask_b32 v11, v11, v12, vcc
    v_lshl_add_u32 v11, v3, 4, v11
    global_store_dwordx4 v11, v[16:19], s[26:27] sc1
L_p_done:
    s_waitcnt lgkmcnt(0)
    s_mul_i32 s33, s34, 0x9e3779b1
    s_add_u32 s33, s33, 0x7f4a7c15
    s_and_b32 s33, s33, 0xfffffff0
    s_or_b32 s33, s33, s35
    s_cmp_lg_u32 s32, 3
    s_cbranch_scc1 L_noid
    s_lshl_b32 s39, s28, 7
    s_lshl_b32 s40, s29, 2
    s_add_u32 s39, s39, s40
    s_add_u32 s39, s39, 8192
    v_mov_b32 v11, s39
    v_mov_b32 v12, s33
    s_mov_b64 exec, 1
    s_setprio 3
    global_store_dword v11, v12, s[26:27] sc1
    s_setprio 0
    s_mov_b64 exec, -1
L_noid:
    s_cmp_ge_u32 s32, 2
    s_cbranch_scc1 L_q_done
    s_cmp_eq_u32 s38, 0
    s_cbranch_scc1 L_q_done
    v_mul_u32_u24 v11, 1040, v9
    v_lshl_add_u32 v11, v2, 4, v11
    v_add_u32 v11, 139264, v11
    s_mov_b32 s3, 1600000
L_wf_x_3:
    ds_read_b32 v7, v6 offset:32
    s_waitcnt lgkmcnt(0)
    v_readfirstlane_b32 s39, v7
    s_nop 0
    s_cmp_ge_u32 s39, 4
    s_cbranch_scc1 L_wfd_x_4
    s_sleep 1
    s_sub_u32 s3, s3, 1
    s_cbranch_scc0 L_wf_x_3
L_wfd_x_4:
    ds_read_b128 v[96:99], v11 offset:0
    ds_read_b128 v[100:103], v11 offset:64
    ds_read_b128 v[104:107], v11 offset:128
    ds_read_b128 v[108:111], v11 offset:192
    ds_read_b128 v[112:115], v11 offset:256
    ds_read_b128 v[116:119], v11 offset:320
    ds_read_b128 v[120:123], v11 offset:384
    ds_read_b128 v[124:127], v11 offset:448
    ds_read_b128 v[128:131], v11 offset:512
    ds_read_b128 v[132:135], v11 offset:576
    ds_read_b128 v[136:139], v11 offset:640
    ds_read_b128 v[140:143], v11 offset:704
    ds_read_b128 v[144:147], v11 offset:768
    ds_read_b128 v[148:151], v11 offset:832
    ds_read_b128 v[152:155], v11 offset:896
    ds_read_b128 v[156:159], v11 offset:960
    v_lshlrev_b32 v12, 9, v2
    v_lshl_add_u32 v12, v13, 6, v12
    v_lshl_add_u32 v12, v9, 3, v12
    s_lshl_b32 s39, s32, 5
    s_add_u32 s39, s39, 73728
    v_add_u32 v12, s39, v12
    s_lshl_b32 s39, s28, 13
    s_lshl_b32 s40, s31, 7
    s_add_u32 s39, s39, s40
    s_lshl_b32 s40, s32, 6
    s_add_u32 s39, s39, s40
    s_add_u32 s39, s39, 65536
    v_lshlrev_b32 v14, 11, v2
    v_lshl_add_u32 v14, v3, 2, v14
    v_add_u32 v14, s39, v14
    v_add_u32 v15, 786432, v14
    v_cmp_eq_u32 s[44:45], 1, v2
    v_cmp_eq_u32 s[46:47], 2, v2
    v_cmp_eq_u32 s[48:49], 3, v2
    v_mov_b32 v25, s33
    s_mov_b32 s3, 1600000
L_wf_wq_5:
    ds_read_b32 v7, v6 offset:0
    s_waitcnt lgkmcnt(0)
    v_readfirstlane_b32 s39, v7
    s_nop 0
    s_cmp_ge_u32 s39, 1
    s_cbranch_scc1 L_wfd_wq_6
    s_sub_u32 s3, s3, 1
    s_cbranch_scc0 L_wf_wq_5
L_wfd_wq_6:
    ds_read_b64_tr_b16 v[32:33], v12 offset:0
    ds_read_b64_tr_b16 v[34:35], v12 offset:256
    ds_read_b64_tr_b16 v[36:37], v12 offset:2048
    ds_read_b64_tr_b16 v[38:39], v12 offset:2304
    ds_read_b64_tr_b16 v[40:41], v12 offset:4096
    ds_read_b64_tr_b16 v[42:43], v12 offset:4352
    ds_read_b64_tr_b16 v[44:45], v12 offset:6144
    ds_read_b64_tr_b16 v[46:47], v12 offset:6400
    ds_read_b64_tr_b16 v[48:49], v12 offset:8192
    ds_read_b64_tr_b16 v[50:51], v12 offset:8448
    ds_read_b64_tr_b16 v[52:53], v12 offset:10240
    ds_read_b64_tr_b16 v[54:55], v12 offset:10496
    ds_read_b64_tr_b16 v[56:57], v12 offset:12288
    ds_read_b64_tr_b16 v[58:59], v12 offset:12544
    s_waitcnt lgkmcnt(12)
    v_mfma_f32_16x16x32_bf16 v[20:23], v[96:99], v[32:35], 0
    ds_read_b64_tr_b16 v[60:61], v12 offset:14336
    ds_read_b64_tr_b16 v[62:63], v12 offset:14592
    s_waitcnt lgkmcnt(12)
    v_mfma_f32_16x16x32_bf16 v[20:23], v[100:103], v[36:39], v[20:23]
    ds_read_b64_tr_b16 v[64:65], v12 offset:16384
    ds_read_b64_tr_b16 v[66:67], v12 offset:16640
    s_waitcnt lgkmcnt(12)
    v_mfma_f32_16x16x32_bf16 v[20:23], v[104:107], v[40:43], v[20:23]
    ds_read_b64_tr_b16 v[68:69], v12 offset:18432
    ds_read_b64_tr_b16 v[70:71], v12 offset:18688
    s_waitcnt lgkmcnt(12)
    v_mfma_f32_16x16x32_bf16 v[20:23], v[108:111], v[44:47], v[20:23]
    ds_read_b64_tr_b16 v[72:73], v12 offset:20480
    ds_read_b64_tr_b16 v[74:75], v12 offset:20736
    s_waitcnt lgkmcnt(12)
    v_mfma_f32_16x16x32_bf16 v[20:23], v[112:115], v[48:51], v[20:23]
    ds_read_b64_tr_b16 v[76:77], v12 offset:22528
    ds_read_b64_tr_b16 v[78:79], v12 offset:22784
    s_waitcnt lgkmcnt(12)
    v_mfma_f32_16x16x32_bf16 v[20:23], v[116:119], v[52:55], v[20:23]
    ds_read_b64_tr_b16 v[80:81], v12 offset:24576
    ds_read_b64_tr_b16 v[82:83], v12 offset:24832
    s_waitcnt lgkmcnt(12)
    v_mfma_f32_16x16x32_bf16 v[20:23], v[120:123], v[56:59], v[20:23]
    ds_read_b64_tr_b16 v[84:85], v12 offset:26624
    ds_read_b64_tr_b16 v[86:87], v12 offset:26880
    s_waitcnt lgkmcnt(12)
    v_mfma_f32_16x16x32_bf16 v[20:23], v[124:127], v[60:63], v[20:23]
    ds_read_b64_tr_b16 v[88:89], v12 offset:28672
    ds_read_b64_tr_b16 v[90:91], v12 offset:28928
    s_waitcnt lgkmcnt(12)
    v_mfma_f32_16x16x32_bf16 v[20:23], v[128:131], v[64:67], v[20:23]
    ds_read_b64_tr_b16 v[92:93], v12 offset:30720
    ds_read_b64_tr_b16 v[94:95], v12 offset:30976
    s_waitcnt lgkmcnt(12)
    v_mfma_f32_16x16x32_bf16 v[20:23], v[132:135], v[68:71], v[20:23]
    s_waitcnt lgkmcnt(10)
    v_mfma_f32_16x16x32_bf16 v[20:23], v[136:139], v[72:75], v[20:23]
    s_waitcnt lgkmcnt(8)
    v_mfma_f32_16x16x32_bf16 v[20:23], v[140:143], v[76:79], v[20:23]
    s_waitcnt lgkmcnt(6)
    v_mfma_f32_16x16x32_bf16 v[20:23], v[144:147], v[80:83], v[20:23]
    s_waitcnt lgkmcnt(4)
    v_mfma_f32_16x16x32_bf16 v[20:23], v[148:151], v[84:87], v[20:23]
    s_waitcnt lgkmcnt(2)
    v_mfma_f32_16x16x32_bf16 v[20:23], v[152:155], v[88:91], v[20:23]
    s_waitcnt lgkmcnt(0)
    v_mfma_f32_16x16x32_bf16 v[20:23], v[156:159], v[92:95], v[20:23]
    s_nop 7
    v_cndmask_b32 v20, v20, v21, s[44:45]
    v_cndmask_b32 v20, v20, v22, s[46:47]
    v_cndmask_b32 v20, v20, v23, s[48:49]
    s_nop 1
    v_mov_b32_dpp v21, v20 quad_perm:[1,1,3,3] row_mask:0xf bank_mask:0xf
    v_cvt_pk_bf16_f32 v24, v20, v21
    s_waitcnt vmcnt(0)
    s_mov_b32 exec_lo, 0x55555555
    s_mov_b32 exec_hi, 0x55555555
    global_store_dwordx2 v14, v[24:25], s[26:27]
    global_store_dwordx2 v15, v[24:25], s[26:27] sc1
    s_mov_b64 exec, -1
    s_mov_b64 exec, 1
    ds_add_u32 v6, v8 offset:12
    s_mov_b64 exec, -1
L_q_done:
    v_lshlrev_b32 v14, 8, v9
    v_lshl_add_u32 v14, v2, 4, v14
    v_add_u32 v14, 147456, v14
    s_lshl_b32 s39, s32, 13
    v_lshl_add_u32 v12, v3, 8, s39
    v_add_u32 v24, 0, v2
    v_xor_b32 v24, v24, v3
    v_lshl_add_u32 v28, v24, 4, v12
    v_add_u32 v24, 4, v2
    v_xor_b32 v24, v24, v3
    v_lshl_add_u32 v29, v24, 4, v12
    v_add_u32 v24, 8, v2
    v_xor_b32 v24, v24, v3
    v_lshl_add_u32 v30, v24, 4, v12
    v_add_u32 v24, 12, v2
    v_xor_b32 v24, v24, v3
    v_lshl_add_u32 v31, v24, 4, v12
    s_lshl_b32 s41, s32, 2
    s_add_u32 s41, s41, 150784
    v_lshl_add_u32 v17, v9, 6, s41
    v_lshlrev_b32 v18, 6, v9
    v_add_u32 v18, 150784, v18
    v_lshlrev_b32 v15, 6, v2
    v_lshl_add_u32 v15, v9, 4, v15
    v_add_u32 v15, 148480, v15
    s_lshl_b32 s40, s32, 8
    v_add_u32 v11, s40, v15
    s_cmp_lt_u32 s32, 8
    s_cbranch_scc1 L_qp_done
    s_cmp_eq_u32 s32, 9
    s_cbranch_scc1 L_service
    v_mov_b32 v143, 0
    v_mov_b32 v144, 0
    v_mov_b32 v145, 0
    v_mov_b32 v146, 0
    v_mov_b32 v147, 0
    v_mov_b32 v148, 0
    v_mov_b32 v149, 0
    v_mov_b32 v150, 0
    v_mov_b32 v151, 0
    v_mov_b32 v152, 0
    v_mov_b32 v153, 0
    v_mov_b32 v154, 0
    v_mov_b32 v155, 0
    v_mov_b32 v156, 0
    v_mov_b32 v157, 0
    v_mov_b32 v158, 0
    v_mov_b32 v159, 0
    v_mov_b32 v160, 0
    v_mov_b32 v161, 0
    v_mov_b32 v162, 0
    v_mov_b32 v163, 0
    v_mov_b32 v164, 0
    v_mov_b32 v165, 0
    v_mov_b32 v166, 0
    v_mov_b32 v10, 0
    v_mov_b32 v16, 0
    v_mov_b32 v4, 0
    s_cmp_eq_u32 s38, 0
    s_cbranch_scc1 L_qk_o
    s_branch L_fin
L_service:
    s_setprio 3
    s_lshl_b32 s39, s28, 13
    s_lshl_b32 s40, s30, 11
    s_add_u32 s39, s39, s40
    s_add_u32 s39, s39, 65536
    v_add_u32 v20, s39, v5
    v_add_u32 v21, 786432, v20
    s_lshl_b32 s39, s28, 7
    s_add_u32 s39, s39, 8192
    v_and_b32 v22, 31, v1
    v_lshl_add_u32 v22, v22, 2, s39
    v_lshlrev_b32 v23, 3, v1
    v_add_u32 v23, 147456, v23
    s_cmp_lg_u32 s38, 0
    s_cbranch_scc1 L_qs_q
    s_mov_b32 s3, 1600000
L_wp_qs_7:
    ds_read_b32 v7, v6 offset:4
    s_waitcnt lgkmcnt(0)
    v_readfirstlane_b32 s39, v7
    s_nop 0
    s_cmp_ge_i32 s39, 8
    s_cbranch_scc1 L_wpd_qs_8
    s_sleep 1
    s_sub_u32 s3, s3, 1
    s_cbranch_scc0 L_wp_qs_7
L_wpd_qs_8:
    s_branch L_qs_done
L_qs_q:
    s_mov_b32 s3, 1600000
L_wf_qs_9:
    ds_read_b32 v7, v6 offset:12
    s_waitcnt lgkmcnt(0)
    v_readfirstlane_b32 s39, v7
    s_nop 0
    s_cmp_ge_u32 s39, 2
    s_cbranch_scc1 L_wfd_qs_10
    s_sleep 1
    s_sub_u32 s3, s3, 1
    s_cbranch_scc0 L_wf_qs_9
L_wfd_qs_10:
L_qs_done:
    global_load_dword v36, v22, s[26:27] sc1
    global_load_dwordx4 v[96:99], v20, s[26:27] sc1
    global_load_dwordx4 v[100:103], v20, s[26:27] offset:1024 sc1
    s_sleep 12
    global_load_dwordx4 v[104:107], v20, s[26:27] sc1
    global_load_dwordx4 v[108:111], v20, s[26:27] offset:1024 sc1
    s_sleep 12
    s_mov_b32 s3, 200000
L_qpoll:
    global_load_dwordx4 v[112:115], v20, s[26:27] sc1
    global_load_dwordx4 v[116:119], v20, s[26:27] offset:1024 sc1
    s_waitcnt vmcnt(4)
    v_xor_b32 v32, s33, v97
    v_xor_b32 v33, s33, v99
    v_xor_b32 v34, s33, v101
    v_xor_b32 v35, s33, v103
    v_or3_b32 v32, v32, v33, v34
    v_or_b32 v32, v32, v35
    v_mov_b32 v24, v96
    v_mov_b32 v25, v98
    v_mov_b32 v26, v100
    v_mov_b32 v27, v102
    v_cmp_lt_u32 vcc, 15, v32
    s_cbranch_vccz L_qok
    s_sleep 2
    global_load_dwordx4 v[120:123], v21, s[26:27] sc1
    global_load_dwordx4 v[124:127], v21, s[26:27] offset:1024 sc1
    s_waitcnt vmcnt(4)
    v_xor_b32 v32, s33, v105
    v_xor_b32 v33, s33, v107
    v_xor_b32 v34, s33, v109
    v_xor_b32 v35, s33, v111
    v_or3_b32 v32, v32, v33, v34
    v_or_b32 v32, v32, v35
    v_mov_b32 v24, v104
    v_mov_b32 v25, v106
    v_mov_b32 v26, v108
    v_mov_b32 v27, v110
    v_cmp_lt_u32 vcc, 15, v32
    s_cbranch_vccz L_qok
    s_sleep 2
    global_load_dwordx4 v[96:99], v20, s[26:27] sc1
    global_load_dwordx4 v[100:103], v20, s[26:27] offset:1024 sc1
    s_waitcnt vmcnt(4)
    v_xor_b32 v32, s33, v113
    v_xor_b32 v33, s33, v115
    v_xor_b32 v34, s33, v117
    v_xor_b32 v35, s33, v119
    v_or3_b32 v32, v32, v33, v34
    v_or_b32 v32, v32, v35
    v_mov_b32 v24, v112
    v_mov_b32 v25, v114
    v_mov_b32 v26, v116
    v_mov_b32 v27, v118
    v_cmp_lt_u32 vcc, 15, v32
    s_cbranch_vccz L_qok
    s_sleep 2
    global_load_dwordx4 v[104:107], v20, s[26:27] sc1
    global_load_dwordx4 v[108:111], v20, s[26:27] offset:1024 sc1
    s_waitcnt vmcnt(4)
    v_xor_b32 v32, s33, v121
    v_xor_b32 v33, s33, v123
    v_xor_b32 v34, s33, v125
    v_xor_b32 v35, s33, v127
    v_or3_b32 v32, v32, v33, v34
    v_or_b32 v32, v32, v35
    v_mov_b32 v24, v120
    v_mov_b32 v25, v122
    v_mov_b32 v26, v124
    v_mov_b32 v27, v126
    v_cmp_lt_u32 vcc, 15, v32
    s_cbranch_vccz L_qok
    s_sleep 2
    s_sub_u32 s3, s3, 1
    s_cbranch_scc0 L_qpoll
L_qok:
    ds_write_b64 v23, v[24:25]
    ds_write_b64 v23, v[26:27] offset:512
    s_mov_b64 exec, 1
    ds_add_u32 v6, v8 offset:16
    s_mov_b64 exec, -1
    s_mov_b32 s3, 200000
L_idchk:
    v_xor_b32 v36, s33, v36
    v_cmp_lt_u32 vcc, 15, v36
    s_cbranch_vccz L_idok
    global_load_dword v36, v22, s[26:27] sc1
    s_waitcnt vmcnt(0)
    s_sub_u32 s3, s3, 1
    s_cbranch_scc0 L_idchk
L_idok:
    v_cmp_ne_u32 vcc, 0, v36
    s_nop 0
    s_or_b32 s35, vcc_lo, vcc_hi
    v_mov_b32 v20, s35
    ds_write_b32 v6, v20 offset:28
    s_mov_b64 exec, 1
    ds_add_u32 v6, v8 offset:24
    s_mov_b64 exec, -1
    s_cmp_lg_u32 s29, 0
    s_cbranch_scc1 L_nocert
    s_lshl_b32 s39, s28, 2
    s_add_u32 s39, s39, 4096
    v_lshl_add_u32 v12, v1, 7, s39
    v_mov_b32 v21, s33
    s_mov_b64 exec, 0xff
    global_store_dword v12, v21, s[26:27] sc1
    s_mov_b64 exec, -1
L_nocert:
    s_lshl_b32 s41, s28, 13
    s_lshl_b32 s40, s29, 3
    s_add_u32 s41, s41, s40
    s_add_u32 s41, s41, 393216
    v_lshl_add_u32 v14, v9, 8, s41
    s_mov_b32 s42, 9
    s_cmp_eq_u32 s38, 0
    s_cbranch_scc1 L_sv_ml
    s_mov_b32 s42, 7
    s_lshl_b32 s41, s28, 17
    s_lshl_b32 s40, s31, 8
    s_add_u32 s41, s41, s40
    s_add_u32 s41, s41, 2097152
    v_lshlrev_b32 v20, 12, v2
    v_lshl_add_u32 v20, v3, 4, v20
    v_add_u32 v20, s41, v20
    s_lshl_b32 s41, s28, 15
    s_lshl_b32 s40, s31, 6
    s_add_u32 s41, s41, s40
    s_add_u32 s41, s41, 917504
    v_lshrrev_b32 v21, 2, v1
    v_lshlrev_b32 v21, 10, v21
    v_lshl_add_u32 v21, v9, 4, v21
    v_add_u32 v21, s41, v21
    v_add_u32 v22, 0x4000, v21
    v_mov_b32 v40, -1
    v_mov_b32 v41, -1
    v_mov_b32 v42, -1
    v_mov_b32 v43, -1
    v_add_u32 v44, 16384, v20
    v_add_u32 v45, 32768, v20
    v_add_u32 v46, 49152, v20
    v_add_u32 v47, 65536, v20
    v_add_u32 v48, 81920, v20
    v_add_u32 v49, 98304, v20
    s_cmp_lg_u32 s35, 0
    s_cbranch_scc1 L_wt_11
    global_store_dwordx4 v20, v[40:43], s[26:27]
    global_store_dwordx4 v44, v[40:43], s[26:27]
    global_store_dwordx4 v45, v[40:43], s[26:27]
    global_store_dwordx4 v46, v[40:43], s[26:27]
    global_store_dwordx4 v47, v[40:43], s[26:27]
    global_store_dwordx4 v48, v[40:43], s[26:27]
    global_store_dwordx4 v49, v[40:43], s[26:27]
    global_store_dwordx4 v21, v[40:43], s[26:27]
    global_store_dwordx4 v22, v[40:43], s[26:27]
L_st_12:
L_sv_ml:
    v_lshrrev_b32 v24, 2, v1
    v_lshl_add_u32 v25, v24, 2, v18
    v_cmp_gt_u32 s[44:45], s42, v24
    s_mov_b32 s3, 1600000
L_wf_svl_13:
    ds_read_b32 v7, v6 offset:20
    s_waitcnt lgkmcnt(0)
    v_readfirstlane_b32 s39, v7
    s_nop 0
    s_cmp_ge_u32 s39, s42
    s_cbranch_scc1 L_wfd_svl_14
    s_sleep 1
    s_sub_u32 s3, s3, 1
    s_cbranch_scc0 L_wf_svl_13
L_wfd_svl_14:
    ds_read_b32 v26, v25
    ds_read_b32 v27, v25 offset:256
    v_mov_b32 v28, 0xff800000
    s_mov_b32 s39, 1069066811
    s_waitcnt lgkmcnt(0)
    v_cndmask_b32 v26, v28, v26, s[44:45]
    v_cndmask_b32 v27, 0, v27, s[44:45]
    s_nop 0
    v_max_f32_dpp v28, v26, v26 row_ror:4 row_mask:0xf bank_mask:0xf
    s_nop 1
    v_max_f32_dpp v28, v28, v28 row_ror:8 row_mask:0xf bank_mask:0xf
    v_mov_b32 v29, v28
    s_nop 1
    v_permlane16_swap_b32 v28, v29
    v_max_f32 v28, v28, v29
    v_mov_b32 v29, v28
    s_nop 1
    v_permlane32_swap_b32 v28, v29
    v_max_f32 v28, v28, v29
    v_sub_f32 v26, v26, v28
    v_mul_f32 v26, s39, v26
    v_exp_f32 v26, v26
    s_nop 0
    v_mul_f32 v29, v27, v26
    s_nop 1
    v_add_f32_dpp v29, v29, v29 row_ror:4 row_mask:0xf bank_mask:0xf
    s_nop 1
    v_add_f32_dpp v29, v29, v29 row_ror:8 row_mask:0xf bank_mask:0xf
    v_mov_b32 v30, v29
    s_nop 1
    v_permlane16_swap_b32 v29, v30
    v_add_f32 v29, v29, v30
    v_mov_b32 v30, v29
    s_nop 1
    v_permlane32_swap_b32 v29, v30
    v_add_f32 v29, v29, v30
    v_min_u32 v28, -2, v28
    v_min_u32 v29, -2, v29
    s_mov_b64 exec, 15
    s_cmp_lg_u32 s35, 0
    s_cbranch_scc1 L_wt_15
    global_store_dwordx2 v14, v[28:29], s[26:27]
L_st_16:
    s_mov_b64 exec, -1
    s_cmp_eq_u32 s38, 0
    s_cbranch_scc1 L_fin
    s_waitcnt vmcnt(1)
    s_barrier
    s_barrier
    s_branch L_fin
L_qp_done:
    v_lshl_add_u32 v12, v2, 2, v13
    v_and_b32 v24, 7, v12
    v_lshlrev_b32 v24, 1, v24
    v_lshrrev_b32 v16, 1, v9
    s_lshl_b32 s40, s32, 1
    v_add_u32 v16, s40, v16
    v_xor_b32 v24, v24, v16
    v_lshlrev_b32 v16, 8, v12
    v_lshl_add_u32 v16, v24, 4, v16
    v_and_b32 v24, 1, v3
    v_lshl_add_u32 v16, v24, 3, v16
    v_add_u32 v16, 73728, v16
    v_add_u32 v4, 0x8000, v16
    s_lshr_b32 s43, s32, 1
    s_and_b32 s46, s32, 1
    s_lshl_b32 s41, s28, 15
    s_lshl_b32 s40, s43, 11
    s_add_u32 s41, s41, s40
    s_lshl_b32 s40, s38, 10
    s_add_u32 s41, s41, s40
    s_lshl_b32 s40, s31, 6
    s_add_u32 s41, s41, s40
    s_lshl_b32 s40, s46, 5
    s_add_u32 s41, s41, s40
    s_add_u32 s41, s41, 131072
    v_lshlrev_b32 v10, 13, v9
    v_lshl_add_u32 v10, v2, 3, v10
    v_add_u32 v10, s41, v10
    s_cmp_lg_u32 s38, 0
    s_cbranch_scc1 L_role_q
    s_lshl_b32 s41, s28, 15
    s_lshl_b32 s40, s32, 12
    s_add_u32 s41, s41, s40
    s_add_u32 s41, s41, 131072
    v_lshlrev_b32 v144, 6, v3
    v_lshl_add_u32 v144, v2, 4, v144
    v_add_u32 v144, s41, v144
    s_lshl_b32 s41, s28, 13
    s_lshl_b32 s40, s43, 8
    s_add_u32 s41, s41, s40
    s_add_u32 s41, s41, 393216
    v_and_b32 v12, 7, v3
    v_lshlrev_b32 v145, 3, v12
    v_lshl_add_u32 v145, v2, 6, v145
    v_add_u32 v145, s41, v145
    v_and_b32 v12, 31, v1
    v_lshlrev_b32 v12, 4, v12
    s_lshl_b32 s41, s31, 12
    s_lshl_b32 s40, s28, 9
    s_add_u32 s41, s41, s40
    s_add_u32 s41, s41, 786432
    v_add_u32 v149, s41, v12
    v_subrev_u32 v148, 262144, v149
    v_lshrrev_b32 v24, 1, v12
    v_sub_u32 v148, v148, v24
    v_lshrrev_b32 v24, 5, v1
    v_lshl_add_u32 v148, v24, 2, v148
    v_lshl_add_u32 v149, v24, 3, v149
    v_lshl_add_u32 v150, v24, 11, v12
    v_add_u32 v150, 152064, v150
    s_lshl_b32 s41, s32, 9
    s_add_u32 s41, s41, 152064
    v_lshl_add_u32 v156, v3, 4, s41
    v_lshl_add_u32 v146, v2, 2, v156
    s_mul_i32 s41, s28, 224
    s_lshl_b32 s42, s32, 5
    s_add_u32 s41, s41, s42
    s_min_u32 s41, s41, 1760
    s_lshl_b32 s41, s41, 10
    s_lshl_b32 s40, s31, 6
    s_add_u32 s41, s41, s40
    s_add_u32 s20, s20, s41
    s_addc_u32 s21, s21, 0
    v_lshrrev_b32 v152, 2, v1
    v_lshlrev_b32 v152, 10, v152
    v_lshl_add_u32 v152, v9, 4, v152
    v_add_u32 v153, 0x4000, v152
    v_add_u32 v157, 0x8000, v152
    v_add_u32 v158, 0xc000, v152
    s_lshl_b32 s41, s28, 19
    s_lshl_b32 s40, s32, 16
    s_add_u32 s41, s41, s40
    s_lshl_b32 s40, s31, 6
    s_add_u32 s41, s41, s40
    s_add_u32 s12, s12, s41
    s_addc_u32 s13, s13, 0
    v_lshlrev_b32 v154, 9, v2
    v_lshl_add_u32 v154, v13, 6, v154
    v_lshl_add_u32 v154, v9, 3, v154
    s_lshl_b32 s49, s32, 12
    s_add_u32 s49, s49, 32768
    v_add_u32 v147, s49, v154
    s_lshl_b32 s47, s32, 11
    v_add_u32 v154, s47, v154
    s_lshl_b32 s41, s28, 13
    s_lshl_b32 s40, s32, 8
    s_add_u32 s41, s41, s40
    s_add_u32 s41, s41, 394240
    v_lshlrev_b32 v155, 4, v9
    v_lshl_add_u32 v155, v2, 6, v155
    v_add_u32 v155, s41, v155
L_qk_o:
    s_lshl_b32 s42, s32, 1
    s_add_u32 s42, s42, 2
    s_mov_b32 s3, 1600000
L_wp_ko_17:
    ds_read_b32 v7, v6 offset:4
    s_waitcnt lgkmcnt(0)
    v_readfirstlane_b32 s39, v7
    s_nop 0
    s_cmp_ge_i32 s39, s42
    s_cbranch_scc1 L_wpd_ko_18
    s_sleep 1
    s_sub_u32 s3, s3, 1
    s_cbranch_scc0 L_wp_ko_17
L_wpd_ko_18:
    ds_read_b128 v[32:35], v28 offset:0
    ds_read_b128 v[48:51], v28 offset:4096
    ds_read_b128 v[36:39], v29 offset:0
    ds_read_b128 v[52:55], v29 offset:4096
    ds_read_b128 v[40:43], v30 offset:0
    ds_read_b128 v[56:59], v30 offset:4096
    ds_read_b128 v[44:47], v31 offset:0
    ds_read_b128 v[60:63], v31 offset:4096
    s_mov_b32 s3, 1600000
L_wf_qlo_19:
    ds_read_b32 v7, v6 offset:16
    s_waitcnt lgkmcnt(0)
    v_readfirstlane_b32 s39, v7
    s_nop 0
    s_cmp_ge_u32 s39, 1
    s_cbranch_scc1 L_wfd_qlo_20
    s_sleep 1
    s_sub_u32 s3, s3, 1
    s_cbranch_scc0 L_wf_qlo_19
L_wfd_qlo_20:
    ds_read_b128 v[64:67], v14 offset:0
    ds_read_b128 v[68:71], v14 offset:64
    ds_read_b128 v[72:75], v14 offset:128
    ds_read_b128 v[76:79], v14 offset:192
    s_waitcnt lgkmcnt(3)
    v_mfma_f32_16x16x32_bf16 v[80:83], v[32:35], v[64:67], 0
    v_mfma_f32_16x16x32_bf16 v[84:87], v[48:51], v[64:67], 0
    s_waitcnt lgkmcnt(2)
    v_mfma_f32_16x16x32_bf16 v[80:83], v[36:39], v[68:71], v[80:83]
    v_mfma_f32_16x16x32_bf16 v[84:87], v[52:55], v[68:71], v[84:87]
    s_waitcnt lgkmcnt(1)
    v_mfma_f32_16x16x32_bf16 v[80:83], v[40:43], v[72:75], v[80:83]
    v_mfma_f32_16x16x32_bf16 v[84:87], v[56:59], v[72:75], v[84:87]
    s_waitcnt lgkmcnt(0)
    v_mfma_f32_16x16x32_bf16 v[80:83], v[44:47], v[76:79], v[80:83]
    v_mfma_f32_16x16x32_bf16 v[84:87], v[60:63], v[76:79], v[84:87]
    s_mov_b32 s40, 1035273459
    s_mov_b32 s41, 1035273459
    s_nop 4
    v_cvt_pk_bf16_f32 v20, v80, v81
    v_cvt_pk_bf16_f32 v21, v82, v83
    v_cvt_pk_bf16_f32 v22, v84, v85
    v_cvt_pk_bf16_f32 v23, v86, v87
    v_lshlrev_b32 v80, 16, v20
    v_and_b32 v81, 0xffff0000, v20
    v_lshlrev_b32 v82, 16, v21
    v_and_b32 v83, 0xffff0000, v21
    v_lshlrev_b32 v84, 16, v22
    v_and_b32 v85, 0xffff0000, v22
    v_lshlrev_b32 v86, 16, v23
    v_and_b32 v87, 0xffff0000, v23
    v_pk_mul_f32 v[80:81], v[80:81], s[40:41]
    v_pk_mul_f32 v[82:83], v[82:83], s[40:41]
    v_pk_mul_f32 v[84:85], v[84:85], s[40:41]
    v_pk_mul_f32 v[86:87], v[86:87], s[40:41]
    v_cvt_pk_bf16_f32 v20, v80, v81
    v_cvt_pk_bf16_f32 v21, v82, v83
    v_cvt_pk_bf16_f32 v22, v84, v85
    v_cvt_pk_bf16_f32 v23, v86, v87
    v_lshlrev_b32 v80, 16, v20
    v_and_b32 v81, 0xffff0000, v20
    v_lshlrev_b32 v82, 16, v21
    v_and_b32 v83, 0xffff0000, v21
    v_lshlrev_b32 v84, 16, v22
    v_and_b32 v85, 0xffff0000, v22
    v_lshlrev_b32 v86, 16, v23
    v_and_b32 v87, 0xffff0000, v23
    v_max3_f32 v12, v80, v81, v82
    v_max3_f32 v14, v83, v84, v85
    v_max3_f32 v12, v12, v86, v87
    v_max_f32 v12, v12, v14
    v_mov_b32 v14, v12
    s_nop 1
    v_permlane16_swap_b32 v12, v14
    v_max_f32 v12, v12, v14
    v_mov_b32 v14, v12
    s_nop 1
    v_permlane32_swap_b32 v12, v14
    v_max_f32 v12, v12, v14
    ds_write_b32 v17, v12
    s_mov_b32 s40, 1069066811
    s_mov_b32 s41, 1069066811
    v_mul_f32 v24, 3216550459, v12
    v_pk_fma_f32 v[80:81], v[80:81], s[40:41], v[24:25] op_sel_hi:[1,1,0]
    v_pk_fma_f32 v[82:83], v[82:83], s[40:41], v[24:25] op_sel_hi:[1,1,0]
    v_pk_fma_f32 v[84:85], v[84:85], s[40:41], v[24:25] op_sel_hi:[1,1,0]
    v_pk_fma_f32 v[86:87], v[86:87], s[40:41], v[24:25] op_sel_hi:[1,1,0]
    v_exp_f32 v80, v80
    v_exp_f32 v81, v81
    v_exp_f32 v82, v82
    v_exp_f32 v83, v83
    v_exp_f32 v84, v84
    v_exp_f32 v85, v85
    v_exp_f32 v86, v86
    v_exp_f32 v87, v87
    v_cvt_pk_bf16_f32 v20, v80, v81
    v_cvt_pk_bf16_f32 v21, v82, v83
    v_cvt_pk_bf16_f32 v22, v84, v85
    v_cvt_pk_bf16_f32 v23, v86, v87
    ds_write_b128 v11, v[20:23]
    s_mov_b64 exec, 1
    ds_add_u32 v6, v8 offset:24
    s_mov_b64 exec, -1
    v_pk_add_f32 v[80:81], v[80:81], v[82:83]
    v_pk_add_f32 v[84:85], v[84:85], v[86:87]
    v_pk_add_f32 v[80:81], v[80:81], v[84:85]
    v_add_f32 v12, v80, v81
    v_mov_b32 v14, v12
    s_nop 1
    v_permlane16_swap_b32 v12, v14
    v_add_f32 v12, v12, v14
    v_mov_b32 v14, v12
    s_nop 1
    v_permlane32_swap_b32 v12, v14
    v_add_f32 v12, v12, v14
    ds_write_b32 v17, v12 offset:256
    s_mov_b64 exec, 1
    ds_add_u32 v6, v8 offset:20
    s_mov_b64 exec, -1
    s_cmp_eq_u32 s32, 8
    s_cbranch_scc1 L_fin
L_noqk_o:
    s_mov_b32 s44, 0x000f000f
    s_mov_b32 s45, 0x000f000f
    s_mov_b32 s40, 1069066811
    s_mov_b32 s41, 1069066811
    s_mov_b32 s3, 1600000
L_wf_s3o_21:
    ds_read_b32 v7, v6 offset:24
    s_waitcnt lgkmcnt(0)
    v_readfirstlane_b32 s39, v7
    s_nop 0
    s_cmp_ge_u32 s39, 10
    s_cbranch_scc1 L_wfd_s3o_22
    s_sub_u32 s3, s3, 1
    s_cbranch_scc0 L_wf_s3o_21
L_wfd_s3o_22:
    ds_read_b32 v7, v6 offset:4
    ds_read_b32 v12, v6 offset:28
    ds_read_b128 v[112:115], v18 offset:0
    ds_read_b128 v[116:119], v18 offset:16
    ds_read_b128 v[120:123], v18 offset:32
    ds_read_b128 v[60:63], v15 offset:0
    ds_read_b128 v[64:67], v15 offset:256
    ds_read_b128 v[68:71], v15 offset:512
    ds_read_b128 v[72:75], v15 offset:768
    ds_read_b128 v[76:79], v15 offset:1024
    ds_read_b128 v[80:83], v15 offset:1280
    ds_read_b128 v[84:87], v15 offset:1536
    ds_read_b128 v[88:91], v15 offset:1792
    ds_read_b128 v[92:95], v15 offset:2048
    s_waitcnt lgkmcnt(12)
    v_readfirstlane_b32 s42, v7
    v_readfirstlane_b32 s35, v12
    s_cmp_lt_i32 s42, 32
    s_cbranch_scc1 L_vlate_o
    s_waitcnt lgkmcnt(9)
    ds_read_b64_tr_b16 v[24:25], v16 offset:0
    ds_read_b64_tr_b16 v[26:27], v16 offset:4096
    ds_read_b64_tr_b16 v[28:29], v16 offset:8192
    ds_read_b64_tr_b16 v[30:31], v16 offset:12288
    ds_read_b64_tr_b16 v[32:33], v16 offset:16384
    ds_read_b64_tr_b16 v[34:35], v16 offset:20480
    ds_read_b64_tr_b16 v[36:37], v16 offset:24576
    ds_read_b64_tr_b16 v[38:39], v16 offset:28672
    ds_read_b64_tr_b16 v[40:41], v4 offset:0
    ds_read_b64_tr_b16 v[42:43], v4 offset:4096
    ds_read_b64_tr_b16 v[44:45], v4 offset:8192
    ds_read_b64_tr_b16 v[46:47], v4 offset:12288
    ds_read_b64_tr_b16 v[48:49], v4 offset:16384
    ds_read_b64_tr_b16 v[50:51], v4 offset:20480
    s_branch L_vgo_o
L_vlate_o:
    s_waitcnt lgkmcnt(9)
L_vgo_o:
    v_max3_f32 v19, v112, v113, v114
    v_max3_f32 v19, v19, v115, v116
    v_max3_f32 v19, v19, v117, v118
    v_max3_f32 v19, v19, v119, v120
    v_mul_f32 v20, 3216550459, v19
    v_pk_fma_f32 v[112:113], v[112:113], s[40:41], v[20:21] op_sel_hi:[1,1,0]
    v_pk_fma_f32 v[114:115], v[114:115], s[40:41], v[20:21] op_sel_hi:[1,1,0]
    v_pk_fma_f32 v[116:117], v[116:117], s[40:41], v[20:21] op_sel_hi:[1,1,0]
    v_pk_fma_f32 v[118:119], v[118:119], s[40:41], v[20:21] op_sel_hi:[1,1,0]
    v_pk_fma_f32 v[120:121], v[120:121], s[40:41], v[20:21] op_sel_hi:[1,1,0]
    v_exp_f32 v132, v112
    v_exp_f32 v133, v113
    v_exp_f32 v134, v114
    v_exp_f32 v135, v115
    v_exp_f32 v136, v116
    v_exp_f32 v137, v117
    v_exp_f32 v138, v118
    v_exp_f32 v139, v119
    v_exp_f32 v140, v120
    s_cmp_ge_i32 s42, 32
    s_cbranch_scc1 L_vin_o
    s_mov_b32 s3, 1600000
L_wp_v1o_23:
    ds_read_b32 v7, v6 offset:4
    s_waitcnt lgkmcnt(0)
    v_readfirstlane_b32 s39, v7
    s_nop 0
    s_cmp_ge_i32 s39, 32
    s_cbranch_scc1 L_wpd_v1o_24
    s_sleep 1
    s_sub_u32 s3, s3, 1
    s_cbranch_scc0 L_wp_v1o_23
L_wpd_v1o_24:
    ds_read_b64_tr_b16 v[24:25], v16 offset:0
    ds_read_b64_tr_b16 v[26:27], v16 offset:4096
    ds_read_b64_tr_b16 v[28:29], v16 offset:8192
    ds_read_b64_tr_b16 v[30:31], v16 offset:12288
    ds_read_b64_tr_b16 v[32:33], v16 offset:16384
    ds_read_b64_tr_b16 v[34:35], v16 offset:20480
    ds_read_b64_tr_b16 v[36:37], v16 offset:24576
    ds_read_b64_tr_b16 v[38:39], v16 offset:28672
    ds_read_b64_tr_b16 v[40:41], v4 offset:0
    ds_read_b64_tr_b16 v[42:43], v4 offset:4096
    ds_read_b64_tr_b16 v[44:45], v4 offset:8192
    ds_read_b64_tr_b16 v[46:47], v4 offset:12288
    ds_read_b64_tr_b16 v[48:49], v4 offset:16384
    ds_read_b64_tr_b16 v[50:51], v4 offset:20480
L_vin_o:
    s_waitcnt lgkmcnt(12)
    v_mfma_f32_16x16x32_bf16 v[60:63], v[24:27], v[60:63], 0
    s_waitcnt lgkmcnt(10)
    v_mfma_f32_16x16x32_bf16 v[64:67], v[28:31], v[64:67], 0
    s_waitcnt lgkmcnt(8)
    v_mfma_f32_16x16x32_bf16 v[68:71], v[32:35], v[68:71], 0
    s_waitcnt lgkmcnt(6)
    v_mfma_f32_16x16x32_bf16 v[72:75], v[36:39], v[72:75], 0
    s_waitcnt lgkmcnt(4)
    v_mfma_f32_16x16x32_bf16 v[76:79], v[40:43], v[76:79], 0
    s_waitcnt lgkmcnt(2)
    v_mfma_f32_16x16x32_bf16 v[80:83], v[44:47], v[80:83], 0
    s_waitcnt lgkmcnt(0)
    v_mfma_f32_16x16x32_bf16 v[84:87], v[48:51], v[84:87], 0
    s_cmp_ge_i32 s42, 36
    s_cbranch_scc1 L_vall_o
    s_mov_b32 s3, 1600000
L_wp_v2o_25:
    ds_read_b32 v7, v6 offset:4
    s_waitcnt lgkmcnt(0)
    v_readfirstlane_b32 s39, v7
    s_nop 0
    s_cmp_ge_i32 s39, 36
    s_cbranch_scc1 L_wpd_v2o_26
    s_sub_u32 s3, s3, 1
    s_cbranch_scc0 L_wp_v2o_25
L_wpd_v2o_26:
L_vall_o:
    ds_read_b64_tr_b16 v[52:53], v4 offset:24576
    ds_read_b64_tr_b16 v[54:55], v4 offset:28672
    ds_read_b64_tr_b16 v[56:57], v4 offset:32768
    ds_read_b64_tr_b16 v[58:59], v4 offset:36864
    v_pk_mul_f32 v[20:21], v[60:61], v[132:133] op_sel:[0,0] op_sel_hi:[1,0]
    v_pk_mul_f32 v[22:23], v[62:63], v[132:133] op_sel:[0,0] op_sel_hi:[1,0]
    v_pk_fma_f32 v[20:21], v[64:65], v[132:133], v[20:21] op_sel:[0,1,0] op_sel_hi:[1,1,1]
    v_pk_fma_f32 v[22:23], v[66:67], v[132:133], v[22:23] op_sel:[0,1,0] op_sel_hi:[1,1,1]
    v_pk_fma_f32 v[20:21], v[68:69], v[134:135], v[20:21] op_sel:[0,0,0] op_sel_hi:[1,0,1]
    v_pk_fma_f32 v[22:23], v[70:71], v[134:135], v[22:23] op_sel:[0,0,0] op_sel_hi:[1,0,1]
    v_pk_fma_f32 v[20:21], v[72:73], v[134:135], v[20:21] op_sel:[0,1,0] op_sel_hi:[1,1,1]
    v_pk_fma_f32 v[22:23], v[74:75], v[134:135], v[22:23] op_sel:[0,1,0] op_sel_hi:[1,1,1]
    v_pk_fma_f32 v[20:21], v[76:77], v[136:137], v[20:21] op_sel:[0,0,0] op_sel_hi:[1,0,1]
    v_pk_fma_f32 v[22:23], v[78:79], v[136:137], v[22:23] op_sel:[0,0,0] op_sel_hi:[1,0,1]
    v_pk_fma_f32 v[20:21], v[80:81], v[136:137], v[20:21] op_sel:[0,1,0] op_sel_hi:[1,1,1]
    v_pk_fma_f32 v[22:23], v[82:83], v[136:137], v[22:23] op_sel:[0,1,0] op_sel_hi:[1,1,1]
    v_pk_fma_f32 v[20:21], v[84:85], v[138:139], v[20:21] op_sel:[0,0,0] op_sel_hi:[1,0,1]
    v_pk_fma_f32 v[22:23], v[86:87], v[138:139], v[22:23] op_sel:[0,0,0] op_sel_hi:[1,0,1]
    s_waitcnt lgkmcnt(2)
    v_mfma_f32_16x16x32_bf16 v[88:91], v[52:55], v[88:91], 0
    s_waitcnt lgkmcnt(0)
    v_mfma_f32_16x16x32_bf16 v[92:95], v[56:59], v[92:95], 0
    s_nop 5
    v_pk_fma_f32 v[20:21], v[88:89], v[138:139], v[20:21] op_sel:[0,1,0] op_sel_hi:[1,1,1]
    v_pk_fma_f32 v[22:23], v[90:91], v[138:139], v[22:23] op_sel:[0,1,0] op_sel_hi:[1,1,1]
    v_pk_fma_f32 v[20:21], v[92:93], v[140:141], v[20:21] op_sel:[0,0,0] op_sel_hi:[1,0,1]
    v_pk_fma_f32 v[22:23], v[94:95], v[140:141], v[22:23] op_sel:[0,0,0] op_sel_hi:[1,0,1]
    v_cvt_pk_bf16_f32 v24, v20, v21
    v_cvt_pk_bf16_f32 v25, v22, v23
    v_min_u32 v24, -2, v24
    v_min_u32 v25, -2, v25
    s_mov_b64 exec, s[44:45]
    s_cmp_lg_u32 s35, 0
    s_cbranch_scc1 L_wt_27
    global_store_dwordx2 v10, v[24:25], s[26:27]
L_st_28:
    s_mov_b64 exec, -1
    s_mov_b32 s3, 1600000
L_wf_wo_29:
    ds_read_b32 v7, v6 offset:8
    s_waitcnt lgkmcnt(0)
    v_readfirstlane_b32 s39, v7
    s_nop 0
    s_cmp_ge_u32 s39, 1
    s_cbranch_scc1 L_wfd_wo_30
    s_sub_u32 s3, s3, 1
    s_cbranch_scc0 L_wf_wo_29
L_wfd_wo_30:
    s_add_u32 m0, s49, 0
    s_nop 0
    global_load_lds_dwordx4 v152, s[12:13]
    s_add_u32 m0, s49, 1024
    s_nop 0
    global_load_lds_dwordx4 v153, s[12:13]
    s_add_u32 m0, s49, 2048
    s_nop 0
    global_load_lds_dwordx4 v157, s[12:13]
    s_add_u32 m0, s49, 3072
    s_nop 0
    global_load_lds_dwordx4 v158, s[12:13]
    s_mov_b32 s41, 1069066811
    s_waitcnt vmcnt(0)
    global_load_dwordx2 v[128:129], v145, s[26:27] sc1
    global_load_dwordx4 v[112:115], v144, s[26:27] offset:0 sc1
    global_load_dwordx4 v[116:119], v144, s[26:27] offset:1024 sc1
    global_load_dwordx4 v[120:123], v144, s[26:27] offset:2048 sc1
    global_load_dwordx4 v[124:127], v144, s[26:27] offset:3072 sc1
    ds_read_b64_tr_b16 v[96:97], v147 offset:0
    ds_read_b64_tr_b16 v[98:99], v147 offset:256
    ds_read_b64_tr_b16 v[100:101], v147 offset:32
    ds_read_b64_tr_b16 v[102:103], v147 offset:288
    ds_read_b64_tr_b16 v[104:105], v147 offset:2048
    ds_read_b64_tr_b16 v[106:107], v147 offset:2304
    ds_read_b64_tr_b16 v[108:109], v147 offset:2080
    ds_read_b64_tr_b16 v[110:111], v147 offset:2336
    s_mov_b32 s3, 200000
    s_waitcnt vmcnt(0)
    s_branch L_chk_h1_33
L_poll_h1_31:
    s_mov_b64 exec, s[56:57]
    s_cbranch_execz L_sk_h1_34
    global_load_dwordx4 v[116:119], v144, s[26:27] offset:1024 sc1
    global_load_dwordx4 v[124:127], v144, s[26:27] offset:3072 sc1
L_sk_h1_34:
    s_mov_b64 exec, s[58:59]
    s_cbranch_execz L_sk_h1_35
    global_load_dwordx4 v[112:115], v144, s[26:27] offset:0 sc1
    global_load_dwordx4 v[120:123], v144, s[26:27] offset:2048 sc1
L_sk_h1_35:
    s_mov_b64 exec, s[60:61]
    s_cbranch_execz L_sk_h1_36
    global_load_dwordx2 v[128:129], v145, s[26:27] sc1
L_sk_h1_36:
    s_mov_b64 exec, -1
    s_waitcnt vmcnt(0)
L_chk_h1_33:
    v_max_u32 v12, v116, v117
    v_max3_u32 v12, v12, v118, v119
    v_max3_u32 v12, v12, v124, v125
    v_max3_u32 v12, v12, v126, v127
    v_cmp_eq_u32 s[56:57], -1, v12
    v_max_u32 v14, v112, v113
    v_max3_u32 v14, v14, v114, v115
    v_max3_u32 v14, v14, v120, v121
    v_max3_u32 v14, v14, v122, v123
    v_cmp_eq_u32 s[58:59], -1, v14
    v_max_u32 v15, v128, v129
    v_cmp_eq_u32 s[60:61], -1, v15
    s_or_b64 vcc, s[56:57], s[58:59]
    s_or_b64 vcc, vcc, s[60:61]
    s_cbranch_scc0 L_done_h1_32
    s_sub_u32 s3, s3, 1
    s_cbranch_scc0 L_poll_h1_31
L_done_h1_32:
    s_waitcnt lgkmcnt(0)
    v_mfma_f32_16x16x32_bf16 v[64:67], v[112:115], v[96:99], 0
    v_max_f32_dpp v22, v128, v128 quad_perm:[1,0,3,2] row_mask:0xf bank_mask:0xf
    v_mfma_f32_16x16x32_bf16 v[68:71], v[112:115], v[100:103], 0
    s_nop 0
    v_max_f32_dpp v22, v22, v22 quad_perm:[2,3,0,1] row_mask:0xf bank_mask:0xf
    v_mfma_f32_16x16x32_bf16 v[72:75], v[116:119], v[96:99], 0
    s_nop 0
    v_max_f32_dpp v22, v22, v22 row_half_mirror row_mask:0xf bank_mask:0xf
    v_mfma_f32_16x16x32_bf16 v[76:79], v[116:119], v[100:103], 0
    v_sub_f32 v20, v128, v22
    v_mul_f32 v20, s41, v20
    v_exp_f32 v20, v20
    v_mfma_f32_16x16x32_bf16 v[64:67], v[120:123], v[104:107], v[64:67]
    v_mul_f32 v21, v129, v20
    v_mfma_f32_16x16x32_bf16 v[68:71], v[120:123], v[108:111], v[68:71]
    s_nop 0
    v_add_f32_dpp v21, v21, v21 quad_perm:[1,0,3,2] row_mask:0xf bank_mask:0xf
    v_mov_b32_dpp v24, v20 row_newbcast:0 row_mask:0xf bank_mask:0xf
    v_mov_b32_dpp v25, v20 row_newbcast:1 row_mask:0xf bank_mask:0xf
    v_mfma_f32_16x16x32_bf16 v[72:75], v[124:127], v[104:107], v[72:75]
    v_add_f32_dpp v21, v21, v21 quad_perm:[2,3,0,1] row_mask:0xf bank_mask:0xf
    v_mov_b32_dpp v26, v20 row_newbcast:2 row_mask:0xf bank_mask:0xf
    v_mov_b32_dpp v27, v20 row_newbcast:3 row_mask:0xf bank_mask:0xf
    v_mfma_f32_16x16x32_bf16 v[76:79], v[124:127], v[108:111], v[76:79]
    v_add_f32_dpp v21, v21, v21 row_half_mirror row_mask:0xf bank_mask:0xf
    v_mov_b32_dpp v28, v20 row_newbcast:4 row_mask:0xf bank_mask:0xf
    v_mov_b32_dpp v29, v20 row_newbcast:5 row_mask:0xf bank_mask:0xf
    v_mov_b32_dpp v30, v20 row_newbcast:6 row_mask:0xf bank_mask:0xf
    v_mov_b32_dpp v31, v20 row_newbcast:7 row_mask:0xf bank_mask:0xf
    v_rcp_f32 v21, v21
    v_pk_mul_f32 v[48:49], v[64:65], v[24:25]
    v_pk_fma_f32 v[48:49], v[66:67], v[26:27], v[48:49]
    v_pk_mul_f32 v[50:51], v[68:69], v[24:25]
    v_pk_fma_f32 v[50:51], v[70:71], v[26:27], v[50:51]
    v_pk_fma_f32 v[48:49], v[72:73], v[28:29], v[48:49]
    v_pk_fma_f32 v[48:49], v[74:75], v[30:31], v[48:49]
    v_pk_fma_f32 v[50:51], v[76:77], v[28:29], v[50:51]
    v_pk_fma_f32 v[50:51], v[78:79], v[30:31], v[50:51]
    v_add_f32 v48, v48, v49
    v_add_f32 v50, v50, v51
    v_mul_f32 v48, v48, v21
    v_mul_f32 v50, v50, v21
    ds_write_b32 v146, v48
    ds_write_b32 v146, v50 offset:256
    s_waitcnt lgkmcnt(0)
    s_barrier
    s_cmp_lg_u32 s32, 0
    s_cbranch_scc1 L_p2_done
    ds_read_b128 v[32:35], v150 offset:0
    ds_read_b128 v[36:39], v150 offset:512
    ds_read_b128 v[40:43], v150 offset:1024
    ds_read_b128 v[44:47], v150 offset:1536
    s_waitcnt lgkmcnt(0)
    v_pk_add_f32 v[32:33], v[32:33], v[36:37]
    v_pk_add_f32 v[34:35], v[34:35], v[38:39]
    v_pk_add_f32 v[40:41], v[40:41], v[44:45]
    v_pk_add_f32 v[42:43], v[42:43], v[46:47]
    v_pk_add_f32 v[32:33], v[32:33], v[40:41]
    v_pk_add_f32 v[34:35], v[34:35], v[42:43]
    s_nop 1
    v_permlane32_swap_b32 v32, v34
    v_permlane32_swap_b32 v33, v35
    v_pk_add_f32 v[32:33], v[32:33], v[34:35]
    v_cvt_pk_bf16_f32 v32, v32, v33
    v_min_u32 v32, -2, v32
    global_store_dword v148, v32, s[26:27] sc1
L_p2_done:
    s_barrier
    s_mov_b32 m0, s47
    s_nop 0
    global_load_lds_dwordx4 v152, s[20:21]
    s_add_u32 m0, s47, 1024
    s_nop 0
    global_load_lds_dwordx4 v153, s[20:21]
    v_mov_b32 v48, 0
    v_mov_b32 v49, 0
    v_mov_b32 v50, 0
    v_mov_b32 v51, 0
    v_mov_b32 v52, 0
    v_mov_b32 v53, 0
    v_mov_b32 v54, 0
    v_mov_b32 v55, 0
    v_cmp_eq_u32 s[58:59], 1, v2
    v_cmp_eq_u32 s[60:61], 2, v2
    v_cmp_eq_u32 s[62:63], 3, v2
    s_lshl_b32 s41, s32, 9
    s_add_u32 s41, s41, 152064
    v_lshl_add_u32 v159, v2, 7, s41
    v_lshl_add_u32 v159, v3, 2, v159
    s_waitcnt vmcnt(0)
    ds_read_b64_tr_b16 v[56:57], v154 offset:0
    ds_read_b64_tr_b16 v[58:59], v154 offset:256
    ds_read_b64_tr_b16 v[60:61], v154 offset:32
    ds_read_b64_tr_b16 v[62:63], v154 offset:288
    s_cmp_eq_u32 s32, 7
    s_cbranch_scc1 L_dn_done
    s_mov_b32 s3, 200000
L_poll_h4_37:
    global_load_dwordx4 v[28:31], v155, s[26:27] sc1
    s_waitcnt vmcnt(0)
L_chk_h4_39:
    v_max_u32 v12, v28, v29
    v_max3_u32 v12, v12, v30, v31
    v_cmp_eq_u32 vcc, -1, v12
    s_nop 0
    s_and_b64 exec, vcc, vcc
    s_cbranch_scc0 L_done_h4_38
    s_sleep 1
    s_sub_u32 s3, s3, 1
    s_cbranch_scc0 L_poll_h4_37
L_done_h4_38:
    s_mov_b64 exec, -1
    s_waitcnt lgkmcnt(0)
    v_mfma_f32_16x16x32_bf16 v[48:51], v[28:31], v[56:59], 0
    v_mfma_f32_16x16x32_bf16 v[52:55], v[28:31], v[60:63], 0
L_dn_done:
    s_nop 6
    v_cndmask_b32 v48, v48, v49, s[58:59]
    v_cndmask_b32 v52, v52, v53, s[58:59]
    v_cndmask_b32 v48, v48, v50, s[60:61]
    v_cndmask_b32 v52, v52, v54, s[60:61]
    v_cndmask_b32 v48, v48, v51, s[62:63]
    v_cndmask_b32 v52, v52, v55, s[62:63]
    ds_write_b32 v159, v48
    ds_write_b32 v159, v52 offset:64
    s_waitcnt lgkmcnt(0)
    s_barrier
    s_cmp_lg_u32 s32, 0
    s_cbranch_scc1 L_fin
    ds_read_b128 v[32:35], v150 offset:0
    ds_read_b128 v[36:39], v150 offset:512
    ds_read_b128 v[40:43], v150 offset:1024
    ds_read_b128 v[44:47], v150 offset:1536
    s_waitcnt lgkmcnt(0)
    v_pk_add_f32 v[32:33], v[32:33], v[36:37]
    v_pk_add_f32 v[34:35], v[34:35], v[38:39]
    v_pk_add_f32 v[40:41], v[40:41], v[44:45]
    v_pk_add_f32 v[42:43], v[42:43], v[46:47]
    v_pk_add_f32 v[32:33], v[32:33], v[40:41]
    v_pk_add_f32 v[34:35], v[34:35], v[42:43]
    s_nop 1
    v_permlane32_swap_b32 v32, v34
    v_permlane32_swap_b32 v33, v35
    v_pk_add_f32 v[32:33], v[32:33], v[34:35]
    v_min_u32 v32, -2, v32
    v_min_u32 v33, -2, v33
    global_store_dwordx2 v149, v[32:33], s[26:27] sc1
    s_branch L_fin
L_role_q:
    s_min_u32 s46, s32, 6
    s_lshl_b32 s41, s28, 17
    s_lshl_b32 s40, s46, 14
    s_add_u32 s41, s41, s40
    s_lshl_b32 s40, s31, 8
    s_add_u32 s41, s41, s40
    s_add_u32 s41, s41, 2097152
    v_lshlrev_b32 v144, 12, v2
    v_lshl_add_u32 v144, v3, 4, v144
    v_add_u32 v144, s41, v144
    s_lshl_b32 s41, s28, 15
    s_lshl_b32 s40, s46, 12
    s_add_u32 s41, s41, s40
    s_lshl_b32 s40, s31, 6
    s_add_u32 s41, s41, s40
    s_add_u32 s41, s41, 917504
    v_lshlrev_b32 v145, 10, v2
    v_lshl_add_u32 v145, v3, 2, v145
    v_add_u32 v145, s41, v145
    s_lshl_b32 s41, s28, 13
    s_lshl_b32 s40, s31, 7
    s_add_u32 s41, s41, s40
    s_add_u32 s41, s41, 397312
    v_lshlrev_b32 v146, 6, v2
    v_lshl_add_u32 v146, v3, 4, v146
    v_add_u32 v146, s41, v146
    s_mul_i32 s41, s31, 114688
    s_mul_i32 s42, s28, 448
    s_add_u32 s41, s41, s42
    s_lshl_b32 s42, s46, 6
    s_add_u32 s41, s41, s42
    s_add_u32 s16, s16, s41
    s_addc_u32 s17, s17, 0
    s_add_u32 s18, s18, s41
    s_addc_u32 s19, s19, 0
    v_lshrrev_b32 v147, 2, v1
    v_mul_u32_u24 v147, 3584, v147
    v_lshl_add_u32 v147, v9, 4, v147
    v_add_u32 v148, 57344, v147
    s_lshl_b32 s47, s32, 12
    v_lshlrev_b32 v149, 9, v2
    v_lshl_add_u32 v149, v13, 6, v149
    v_and_b32 v12, 1, v3
    v_lshl_add_u32 v149, v12, 3, v149
    v_and_b32 v12, 2, v3
    v_lshl_add_u32 v149, v12, 10, v149
    v_add_u32 v149, s47, v149
    v_lshlrev_b32 v12, 6, v9
    v_lshl_add_u32 v12, v2, 4, v12
    v_add_u32 v12, 151552, v12
    v_mov_b32 v24, 151872
    v_cmp_eq_u32 vcc, 0, v13
    s_nop 1
    v_cndmask_b32 v150, v24, v12, vcc
    v_cmp_eq_u32 vcc, 1, v13
    s_nop 1
    v_cndmask_b32 v151, v24, v12, vcc
    v_cmp_eq_u32 vcc, 2, v13
    s_nop 1
    v_cndmask_b32 v152, v24, v12, vcc
    v_cmp_eq_u32 vcc, 3, v13
    s_nop 1
    v_cndmask_b32 v153, v24, v12, vcc
    v_mov_b32 v12, 151808
    v_cmp_eq_u32 vcc, 4, v3
    s_nop 1
    v_cndmask_b32 v154, v150, v12, vcc
    v_mov_b32 v24, 0x3f803f80
    v_and_b32 v12, 31, v1
    v_cmp_gt_u32 vcc, 16, v12
    s_nop 1
    v_cndmask_b32 v24, 0, v24, vcc
    v_lshlrev_b32 v12, 2, v12
    v_add_u32 v12, 151808, v12
    ds_write_b32 v12, v24
    s_lshl_b32 s41, s31, 12
    s_add_u32 s41, s41, 786432
    v_add_u32 v155, s41, v5
    v_subrev_u32 v156, 262144, v155
    v_and_b32 v12, 31, v1
    v_lshlrev_b32 v12, 3, v12
    v_sub_u32 v156, v156, v12
    s_lshr_b32 s43, s28, 1
    s_lshl_b32 s42, s43, 7
    s_add_u32 s42, s42, s41
    v_lshlrev_b32 v155, 9, v2
    v_lshl_add_u32 v155, v3, 3, v155
    v_add_u32 v155, s42, v155
    s_lshl_b32 s42, s43, 6
    s_add_u32 s42, s42, 151552
    v_lshl_add_u32 v160, v3, 2, s42
    s_lshl_b32 s42, s43, 10
    s_lshl_b32 s40, s31, 6
    s_add_u32 s42, s42, s40
    v_lshl_add_u32 v143, v3, 2, s42
    v_and_b32 v12, 31, v1
    v_lshlrev_b32 v12, 1, v12
    v_lshrrev_b32 v24, 5, v1
    v_lshl_add_u32 v157, v24, 11, v12
    s_lshl_b32 s41, s31, 6
    v_add_u32 v157, s41, v157
    v_lshl_add_u32 v158, v24, 7, v12
    v_add_u32 v158, 151552, v158
    v_add_u32 v159, 65536, v157
    s_lshl_b32 s41, s28, 7
    s_add_u32 s41, s41, 4096
    v_and_b32 v12, 7, v1
    v_lshl_add_u32 v161, v12, 2, s41
    s_and_b32 s42, s32, 1
    s_lshl_b32 s48, s31, 1
    s_add_u32 s48, s48, s42
    s_min_u32 s48, s48, 27
    s_lshl_b32 s41, s28, 17
    s_lshl_b32 s40, s48, 12
    s_add_u32 s41, s41, s40
    s_add_u32 s41, s41, 2097152
    v_add_u32 v162, s41, v5
    s_lshl_b32 s41, s28, 15
    s_lshl_b32 s40, s48, 10
    s_add_u32 s41, s41, s40
    s_add_u32 s41, s41, 917504
    v_lshl_add_u32 v163, v1, 2, s41
    s_lshl_b32 s41, s28, 13
    s_add_u32 s41, s41, 397312
    v_lshl_add_u32 v165, v3, 7, s41
    v_mul_u32_u24 v24, 20, v2
    v_add_u32 v164, v165, v24
    v_lshl_add_u32 v165, v2, 4, v165
    s_lshl_b32 s41, s28, 13
    s_lshl_b32 s40, s48, 6
    s_add_u32 s41, s41, s40
    s_add_u32 s41, s41, 394240
    v_lshlrev_b32 v166, 4, v2
    v_lshl_add_u32 v166, v3, 1, v166
    v_add_u32 v166, s41, v166
    s_cmp_ge_u32 s32, 7
    s_cbranch_scc1 L_noqk_q
L_qk_q:
    s_mov_b32 s3, 1600000
L_wf_qlq_40:
    ds_read_b32 v7, v6 offset:16
    s_waitcnt lgkmcnt(0)
    v_readfirstlane_b32 s39, v7
    s_nop 0
    s_cmp_ge_u32 s39, 1
    s_cbranch_scc1 L_wfd_qlq_41
    s_sleep 1
    s_sub_u32 s3, s3, 1
    s_cbranch_scc0 L_wf_qlq_40
L_wfd_qlq_41:
    ds_read_b128 v[64:67], v14 offset:0
    ds_read_b128 v[68:71], v14 offset:64
    ds_read_b128 v[72:75], v14 offset:128
    ds_read_b128 v[76:79], v14 offset:192
    s_lshl_b32 s42, s32, 1
    s_add_u32 s42, s42, 2
    s_mov_b32 s3, 1600000
L_wp_kq_42:
    ds_read_b32 v7, v6 offset:4
    s_waitcnt lgkmcnt(0)
    v_readfirstlane_b32 s39, v7
    s_nop 0
    s_cmp_ge_i32 s39, s42
    s_cbranch_scc1 L_wpd_kq_43
    s_sleep 1
    s_sub_u32 s3, s3, 1
    s_cbranch_scc0 L_wp_kq_42
L_wpd_kq_43:
    ds_read_b128 v[32:35], v28 offset:0
    ds_read_b128 v[48:51], v28 offset:4096
    ds_read_b128 v[36:39], v29 offset:0
    ds_read_b128 v[52:55], v29 offset:4096
    ds_read_b128 v[40:43], v30 offset:0
    ds_read_b128 v[56:59], v30 offset:4096
    ds_read_b128 v[44:47], v31 offset:0
    ds_read_b128 v[60:63], v31 offset:4096
    s_waitcnt lgkmcnt(7)
    v_mfma_f32_16x16x32_bf16 v[80:83], v[32:35], v[64:67], 0
    s_waitcnt lgkmcnt(6)
    v_mfma_f32_16x16x32_bf16 v[84:87], v[48:51], v[64:67], 0
    s_waitcnt lgkmcnt(5)
    v_mfma_f32_16x16x32_bf16 v[80:83], v[36:39], v[68:71], v[80:83]
    s_waitcnt lgkmcnt(4)
    v_mfma_f32_16x16x32_bf16 v[84:87], v[52:55], v[68:71], v[84:87]
    s_waitcnt lgkmcnt(3)
    v_mfma_f32_16x16x32_bf16 v[80:83], v[40:43], v[72:75], v[80:83]
    s_waitcnt lgkmcnt(2)
    v_mfma_f32_16x16x32_bf16 v[84:87], v[56:59], v[72:75], v[84:87]
    s_waitcnt lgkmcnt(1)
    v_mfma_f32_16x16x32_bf16 v[80:83], v[44:47], v[76:79], v[80:83]
    s_waitcnt lgkmcnt(0)
    v_mfma_f32_16x16x32_bf16 v[84:87], v[60:63], v[76:79], v[84:87]
    s_mov_b32 s40, 1035273459
    s_mov_b32 s41, 1035273459
    s_nop 3
    v_cvt_pk_bf16_f32 v20, v80, v81
    v_cvt_pk_bf16_f32 v21, v82, v83
    v_cvt_pk_bf16_f32 v22, v84, v85
    v_cvt_pk_bf16_f32 v23, v86, v87
    v_lshlrev_b32 v80, 16, v20
    v_and_b32 v81, 0xffff0000, v20
    v_lshlrev_b32 v82, 16, v21
    v_and_b32 v83, 0xffff0000, v21
    v_lshlrev_b32 v84, 16, v22
    v_and_b32 v85, 0xffff0000, v22
    v_lshlrev_b32 v86, 16, v23
    v_and_b32 v87, 0xffff0000, v23
    v_pk_mul_f32 v[80:81], v[80:81], s[40:41]
    v_pk_mul_f32 v[82:83], v[82:83], s[40:41]
    v_pk_mul_f32 v[84:85], v[84:85], s[40:41]
    v_pk_mul_f32 v[86:87], v[86:87], s[40:41]
    v_cvt_pk_bf16_f32 v20, v80, v81
    v_cvt_pk_bf16_f32 v21, v82, v83
    v_cvt_pk_bf16_f32 v22, v84, v85
    v_cvt_pk_bf16_f32 v23, v86, v87
    v_lshlrev_b32 v80, 16, v20
    v_and_b32 v81, 0xffff0000, v20
    v_lshlrev_b32 v82, 16, v21
    v_and_b32 v83, 0xffff0000, v21
    v_lshlrev_b32 v84, 16, v22
    v_and_b32 v85, 0xffff0000, v22
    v_lshlrev_b32 v86, 16, v23
    v_and_b32 v87, 0xffff0000, v23
    v_max3_f32 v12, v80, v81, v82
    v_max3_f32 v14, v83, v84, v85
    v_max3_f32 v12, v12, v86, v87
    v_max_f32 v12, v12, v14
    v_mov_b32 v14, v12
    s_nop 1
    v_permlane16_swap_b32 v12, v14
    v_max_f32 v12, v12, v14
    v_mov_b32 v14, v12
    s_nop 1
    v_permlane32_swap_b32 v12, v14
    v_max_f32 v12, v12, v14
    ds_write_b32 v17, v12
    s_mov_b32 s40, 1069066811
    s_mov_b32 s41, 1069066811
    v_mul_f32 v24, 3216550459, v12
    v_pk_fma_f32 v[80:81], v[80:81], s[40:41], v[24:25] op_sel_hi:[1,1,0]
    v_pk_fma_f32 v[82:83], v[82:83], s[40:41], v[24:25] op_sel_hi:[1,1,0]
    v_pk_fma_f32 v[84:85], v[84:85], s[40:41], v[24:25] op_sel_hi:[1,1,0]
    v_pk_fma_f32 v[86:87], v[86:87], s[40:41], v[24:25] op_sel_hi:[1,1,0]
    v_exp_f32 v80, v80
    v_exp_f32 v81, v81
    v_exp_f32 v82, v82
    v_exp_f32 v83, v83
    v_exp_f32 v84, v84
    v_exp_f32 v85, v85
    v_exp_f32 v86, v86
    v_exp_f32 v87, v87
    v_cvt_pk_bf16_f32 v20, v80, v81
    v_cvt_pk_bf16_f32 v21, v82, v83
    v_cvt_pk_bf16_f32 v22, v84, v85
    v_cvt_pk_bf16_f32 v23, v86, v87
    ds_write_b128 v11, v[20:23]
    s_mov_b64 exec, 1
    ds_add_u32 v6, v8 offset:24
    s_mov_b64 exec, -1
    v_pk_add_f32 v[80:81], v[80:81], v[82:83]
    v_pk_add_f32 v[84:85], v[84:85], v[86:87]
    v_pk_add_f32 v[80:81], v[80:81], v[84:85]
    v_add_f32 v12, v80, v81
    v_mov_b32 v14, v12
    s_nop 1
    v_permlane16_swap_b32 v12, v14
    v_add_f32 v12, v12, v14
    v_mov_b32 v14, v12
    s_nop 1
    v_permlane32_swap_b32 v12, v14
    v_add_f32 v12, v12, v14
    ds_write_b32 v17, v12 offset:256
    s_mov_b64 exec, 1
    ds_add_u32 v6, v8 offset:20
    s_mov_b64 exec, -1
L_noqk_q:
    s_mov_b32 s44, 0x000f000f
    s_mov_b32 s45, 0x000f000f
    s_mov_b32 s40, 1069066811
    s_mov_b32 s41, 1069066811
    s_mov_b32 s3, 1600000
L_wf_s3q_44:
    ds_read_b32 v7, v6 offset:24
    s_waitcnt lgkmcnt(0)
    v_readfirstlane_b32 s39, v7
    s_nop 0
    s_cmp_ge_u32 s39, 8
    s_cbranch_scc1 L_wfd_s3q_45
    s_sub_u32 s3, s3, 1
    s_cbranch_scc0 L_wf_s3q_44
L_wfd_s3q_45:
    ds_read_b32 v7, v6 offset:4
    ds_read_b32 v12, v6 offset:28
    ds_read_b128 v[112:115], v18 offset:0
    ds_read_b128 v[116:119], v18 offset:16
    ds_read_b128 v[60:63], v15 offset:0
    ds_read_b128 v[64:67], v15 offset:256
    ds_read_b128 v[68:71], v15 offset:512
    ds_read_b128 v[72:75], v15 offset:768
    ds_read_b128 v[76:79], v15 offset:1024
    ds_read_b128 v[80:83], v15 offset:1280
    ds_read_b128 v[84:87], v15 offset:1536
    s_waitcnt lgkmcnt(9)
    v_readfirstlane_b32 s42, v7
    v_readfirstlane_b32 s35, v12
    s_cmp_lt_i32 s42, 24
    s_cbranch_scc1 L_vlate_q
    s_waitcnt lgkmcnt(7)
    ds_read_b64_tr_b16 v[24:25], v16 offset:0
    ds_read_b64_tr_b16 v[26:27], v16 offset:4096
    ds_read_b64_tr_b16 v[28:29], v16 offset:8192
    ds_read_b64_tr_b16 v[30:31], v16 offset:12288
    ds_read_b64_tr_b16 v[32:33], v16 offset:16384
    ds_read_b64_tr_b16 v[34:35], v16 offset:20480
    ds_read_b64_tr_b16 v[36:37], v16 offset:24576
    ds_read_b64_tr_b16 v[38:39], v16 offset:28672
    ds_read_b64_tr_b16 v[40:41], v4 offset:0
    ds_read_b64_tr_b16 v[42:43], v4 offset:4096
    s_branch L_vgo_q
L_vlate_q:
    s_waitcnt lgkmcnt(7)
L_vgo_q:
    v_max3_f32 v19, v112, v113, v114
    v_max3_f32 v19, v19, v115, v116
    v_max3_f32 v19, v19, v117, v118
    v_mul_f32 v20, 3216550459, v19
    v_pk_fma_f32 v[112:113], v[112:113], s[40:41], v[20:21] op_sel_hi:[1,1,0]
    v_pk_fma_f32 v[114:115], v[114:115], s[40:41], v[20:21] op_sel_hi:[1,1,0]
    v_pk_fma_f32 v[116:117], v[116:117], s[40:41], v[20:21] op_sel_hi:[1,1,0]
    v_pk_fma_f32 v[118:119], v[118:119], s[40:41], v[20:21] op_sel_hi:[1,1,0]
    v_exp_f32 v132, v112
    v_exp_f32 v133, v113
    v_exp_f32 v134, v114
    v_exp_f32 v135, v115
    v_exp_f32 v136, v116
    v_exp_f32 v137, v117
    v_exp_f32 v138, v118
    s_cmp_ge_i32 s42, 24
    s_cbranch_scc1 L_vin_q
    s_mov_b32 s3, 1600000
L_wp_v1q_46:
    ds_read_b32 v7, v6 offset:4
    s_waitcnt lgkmcnt(0)
    v_readfirstlane_b32 s39, v7
    s_nop 0
    s_cmp_ge_i32 s39, 24
    s_cbranch_scc1 L_wpd_v1q_47
    s_sleep 1
    s_sub_u32 s3, s3, 1
    s_cbranch_scc0 L_wp_v1q_46
L_wpd_v1q_47:
    ds_read_b64_tr_b16 v[24:25], v16 offset:0
    ds_read_b64_tr_b16 v[26:27], v16 offset:4096
    ds_read_b64_tr_b16 v[28:29], v16 offset:8192
    ds_read_b64_tr_b16 v[30:31], v16 offset:12288
    ds_read_b64_tr_b16 v[32:33], v16 offset:16384
    ds_read_b64_tr_b16 v[34:35], v16 offset:20480
    ds_read_b64_tr_b16 v[36:37], v16 offset:24576
    ds_read_b64_tr_b16 v[38:39], v16 offset:28672
    ds_read_b64_tr_b16 v[40:41], v4 offset:0
    ds_read_b64_tr_b16 v[42:43], v4 offset:4096
L_vin_q:
    s_waitcnt lgkmcnt(8)
    v_mfma_f32_16x16x32_bf16 v[60:63], v[24:27], v[60:63], 0
    s_waitcnt lgkmcnt(6)
    v_mfma_f32_16x16x32_bf16 v[64:67], v[28:31], v[64:67], 0
    s_waitcnt lgkmcnt(4)
    v_mfma_f32_16x16x32_bf16 v[68:71], v[32:35], v[68:71], 0
    s_waitcnt lgkmcnt(2)
    v_mfma_f32_16x16x32_bf16 v[72:75], v[36:39], v[72:75], 0
    s_waitcnt lgkmcnt(0)
    v_mfma_f32_16x16x32_bf16 v[76:79], v[40:43], v[76:79], 0
    v_pk_mul_f32 v[20:21], v[60:61], v[132:133] op_sel:[0,0] op_sel_hi:[1,0]
    v_pk_mul_f32 v[22:23], v[62:63], v[132:133] op_sel:[0,0] op_sel_hi:[1,0]
    v_pk_fma_f32 v[20:21], v[64:65], v[132:133], v[20:21] op_sel:[0,1,0] op_sel_hi:[1,1,1]
    v_pk_fma_f32 v[22:23], v[66:67], v[132:133], v[22:23] op_sel:[0,1,0] op_sel_hi:[1,1,1]
    v_pk_fma_f32 v[20:21], v[68:69], v[134:135], v[20:21] op_sel:[0,0,0] op_sel_hi:[1,0,1]
    v_pk_fma_f32 v[22:23], v[70:71], v[134:135], v[22:23] op_sel:[0,0,0] op_sel_hi:[1,0,1]
    v_pk_fma_f32 v[20:21], v[72:73], v[134:135], v[20:21] op_sel:[0,1,0] op_sel_hi:[1,1,1]
    v_pk_fma_f32 v[22:23], v[74:75], v[134:135], v[22:23] op_sel:[0,1,0] op_sel_hi:[1,1,1]
    v_pk_fma_f32 v[20:21], v[76:77], v[136:137], v[20:21] op_sel:[0,0,0] op_sel_hi:[1,0,1]
    v_pk_fma_f32 v[22:23], v[78:79], v[136:137], v[22:23] op_sel:[0,0,0] op_sel_hi:[1,0,1]
    s_barrier
    ds_read_b64_tr_b16 v[44:45], v4 offset:8192
    ds_read_b64_tr_b16 v[46:47], v4 offset:12288
    ds_read_b64_tr_b16 v[48:49], v4 offset:16384
    ds_read_b64_tr_b16 v[50:51], v4 offset:20480
    s_waitcnt lgkmcnt(2)
    v_mfma_f32_16x16x32_bf16 v[80:83], v[44:47], v[80:83], 0
    s_waitcnt lgkmcnt(0)
    v_mfma_f32_16x16x32_bf16 v[84:87], v[48:51], v[84:87], 0
    s_nop 5
    v_pk_fma_f32 v[20:21], v[80:81], v[136:137], v[20:21] op_sel:[0,1,0] op_sel_hi:[1,1,1]
    v_pk_fma_f32 v[22:23], v[82:83], v[136:137], v[22:23] op_sel:[0,1,0] op_sel_hi:[1,1,1]
    v_pk_fma_f32 v[20:21], v[84:85], v[138:139], v[20:21] op_sel:[0,0,0] op_sel_hi:[1,0,1]
    v_pk_fma_f32 v[22:23], v[86:87], v[138:139], v[22:23] op_sel:[0,0,0] op_sel_hi:[1,0,1]
    v_cvt_pk_bf16_f32 v24, v20, v21
    v_cvt_pk_bf16_f32 v25, v22, v23
    v_min_u32 v24, -2, v24
    v_min_u32 v25, -2, v25
    s_mov_b64 exec, s[44:45]
    s_cmp_lg_u32 s35, 0
    s_cbranch_scc1 L_wt_48
    global_store_dwordx2 v10, v[24:25], s[26:27]
L_st_49:
    s_mov_b64 exec, -1
    s_barrier
    s_cmp_eq_u32 s32, 7
    s_cbranch_scc1 L_h2
    s_mov_b32 m0, s47
    s_nop 0
    global_load_lds_dwordx4 v147, s[16:17]
    s_add_u32 m0, s47, 1024
    s_nop 0
    global_load_lds_dwordx4 v148, s[16:17]
    s_add_u32 m0, s47, 2048
    s_nop 0
    global_load_lds_dwordx4 v147, s[18:19]
    s_add_u32 m0, s47, 3072
    s_nop 0
    global_load_lds_dwordx4 v148, s[18:19]
    v_mov_b32 v24, 0x3f803f80
    v_cmp_eq_u32 vcc, 0, v3
    s_nop 1
    v_cndmask_b32 v32, 0, v24, vcc
    v_mov_b32 v33, v32
    v_mov_b32 v34, v32
    v_mov_b32 v35, v32
    v_cmp_eq_u32 vcc, 4, v3
    s_nop 1
    v_cndmask_b32 v36, 0, v24, vcc
    v_mov_b32 v37, v36
    v_mov_b32 v38, v36
    v_mov_b32 v39, v36
    v_cmp_eq_u32 vcc, 8, v3
    s_nop 1
    v_cndmask_b32 v40, 0, v24, vcc
    v_mov_b32 v41, v40
    v_mov_b32 v42, v40
    v_mov_b32 v43, v40
    v_cmp_eq_u32 vcc, 12, v3
    s_nop 1
    v_cndmask_b32 v44, 0, v24, vcc
    v_mov_b32 v45, v44
    v_mov_b32 v46, v44
    v_mov_b32 v47, v44
    s_waitcnt vmcnt(0)
    ds_read_b64_tr_b16 v[96:97], v149 offset:0
    ds_read_b64_tr_b16 v[98:99], v149 offset:256
    ds_read_b64_tr_b16 v[100:101], v149 offset:16
    ds_read_b64_tr_b16 v[102:103], v149 offset:272
    ds_read_b64_tr_b16 v[104:105], v149 offset:32
    ds_read_b64_tr_b16 v[106:107], v149 offset:288
    ds_read_b64_tr_b16 v[108:109], v149 offset:48
    ds_read_b64_tr_b16 v[110:111], v149 offset:304
    s_waitcnt lgkmcnt(6)
    v_mfma_f32_16x16x32_bf16 v[20:23], v[32:35], v[96:99], 0
    s_waitcnt lgkmcnt(4)
    v_mfma_f32_16x16x32_bf16 v[20:23], v[36:39], v[100:103], v[20:23]
    s_waitcnt lgkmcnt(2)
    v_mfma_f32_16x16x32_bf16 v[20:23], v[40:43], v[104:107], v[20:23]
    s_waitcnt lgkmcnt(0)
    v_mfma_f32_16x16x32_bf16 v[20:23], v[44:47], v[108:111], v[20:23]
    s_nop 7
    v_min_u32 v20, -2, v20
    s_cmp_lg_u32 s35, 0
    s_cbranch_scc1 L_wt_50
    global_store_dword v145, v20, s[26:27]
L_st_51:
    s_mov_b32 s41, 3216550459
    s_mov_b32 s44, 0x00550055
    s_mov_b32 s45, 0x00550055
    s_branch L_h2_done
L_h2:
    s_min_u32 s43, s31, 13
    s_lshl_b32 s42, s28, 17
    s_lshl_b32 s40, s43, 13
    s_add_u32 s42, s42, s40
    s_add_u32 s42, s42, 2097152
    v_lshl_add_u32 v23, v1, 7, s42
    global_load_dword v50, v23, s[26:27] sc1
    s_lshl_b32 s42, s28, 15
    s_lshl_b32 s40, s43, 11
    s_add_u32 s42, s42, s40
    s_add_u32 s42, s42, 917504
    s_lshl_b32 s43, s28, 13
    s_add_u32 s43, s43, 397312
    v_mov_b32 v23, s42
    v_mov_b32 v24, s43
    v_and_b32 v25, 16, v1
    v_cmp_eq_u32 vcc, 0, v25
    s_nop 1
    v_cndmask_b32 v23, v24, v23, vcc
    v_lshl_add_u32 v23, v3, 7, v23
    global_load_dword v51, v23, s[26:27] sc1
    ds_read_u16 v24, v159
    ds_read_u16 v25, v159 offset:1024
    s_mov_b32 s3, 200000
L_certpoll:
    global_load_dword v20, v161, s[26:27] sc1
    s_waitcnt vmcnt(0)
    v_xor_b32 v20, s33, v20
    v_cmp_lt_u32 vcc, 15, v20
    s_cbranch_vccz L_cert_ok
    s_sleep 4
    s_sub_u32 s3, s3, 1
    s_cbranch_scc0 L_certpoll
L_cert_ok:
    s_waitcnt lgkmcnt(0)
    v_lshlrev_b32 v24, 16, v24
    v_lshlrev_b32 v25, 16, v25
    v_mov_b32 v58, 0
    v_mov_b32 v59, 0
    v_mov_b32 v48, -1
    v_mov_b32 v49, -1
    v_mov_b32 v50, -1
    v_mov_b32 v51, -1
    v_mov_b32 v52, -1
    v_mov_b32 v53, -1
    v_mov_b32 v54, -1
    v_mov_b32 v55, -1
    v_mov_b32 v64, -1
    v_mov_b32 v65, -1
    v_mov_b32 v66, -1
    v_mov_b32 v67, -1
    v_mov_b32 v68, -1
    v_mov_b32 v69, -1
    v_mov_b32 v70, -1
    v_mov_b32 v71, -1
    v_mov_b32 v72, -1
    v_mov_b32 v73, -1
    v_mov_b32 v74, -1
    v_mov_b32 v75, -1
    v_mov_b32 v76, -1
    v_mov_b32 v77, -1
    v_mov_b32 v78, -1
    v_mov_b32 v79, -1
    s_mov_b64 s[56:57], -1
    s_mov_b64 s[58:59], -1
    s_mov_b64 s[60:61], -1
    s_mov_b64 s[62:63], -1
    s_or_b64 exec, s[56:57], 1
    global_atomic_add_x2 v[64:65], v156, v[58:59], s[26:27] offset:0 sc0
    s_or_b64 exec, s[58:59], 1
    global_atomic_add_x2 v[66:67], v156, v[58:59], s[26:27] offset:1024 sc0
    s_or_b64 exec, s[60:61], 1
    global_atomic_add_x2 v[68:69], v156, v[58:59], s[26:27] offset:2048 sc0
    s_or_b64 exec, s[62:63], 1
    global_atomic_add_x2 v[70:71], v156, v[58:59], s[26:27] offset:3072 sc0
    s_mov_b64 exec, -1
    s_sleep 7
    s_mov_b32 s3, 200000
L_p2l:
    s_or_b64 exec, s[56:57], 1
    global_atomic_add_x2 v[72:73], v156, v[58:59], s[26:27] offset:0 sc0
    s_or_b64 exec, s[58:59], 1
    global_atomic_add_x2 v[74:75], v156, v[58:59], s[26:27] offset:1024 sc0
    s_or_b64 exec, s[60:61], 1
    global_atomic_add_x2 v[76:77], v156, v[58:59], s[26:27] offset:2048 sc0
    s_or_b64 exec, s[62:63], 1
    global_atomic_add_x2 v[78:79], v156, v[58:59], s[26:27] offset:3072 sc0
    s_mov_b64 exec, -1
    s_waitcnt vmcnt(4)
    v_cndmask_b32 v48, v48, v64, s[56:57]
    v_cndmask_b32 v49, v49, v65, s[56:57]
    v_cndmask_b32 v50, v50, v66, s[58:59]
    v_cndmask_b32 v51, v51, v67, s[58:59]
    v_cndmask_b32 v52, v52, v68, s[60:61]
    v_cndmask_b32 v53, v53, v69, s[60:61]
    v_cndmask_b32 v54, v54, v70, s[62:63]
    v_cndmask_b32 v55, v55, v71, s[62:63]
    v_max_u32 v12, v48, v49
    v_max_u32 v14, v50, v51
    v_max_u32 v15, v52, v53
    v_max_u32 v16, v54, v55
    v_cmp_eq_u32 s[56:57], -1, v12
    v_cmp_eq_u32 s[58:59], -1, v14
    v_cmp_eq_u32 s[60:61], -1, v15
    v_cmp_eq_u32 s[62:63], -1, v16
    s_or_b64 vcc, s[56:57], s[58:59]
    s_or_b64 s[64:65], s[60:61], s[62:63]
    s_or_b64 vcc, vcc, s[64:65]
    s_cbranch_scc0 L_p2d
    s_or_b64 exec, s[56:57], 1
    global_atomic_add_x2 v[64:65], v156, v[58:59], s[26:27] offset:0 sc0
    s_or_b64 exec, s[58:59], 1
    global_atomic_add_x2 v[66:67], v156, v[58:59], s[26:27] offset:1024 sc0
    s_or_b64 exec, s[60:61], 1
    global_atomic_add_x2 v[68:69], v156, v[58:59], s[26:27] offset:2048 sc0
    s_or_b64 exec, s[62:63], 1
    global_atomic_add_x2 v[70:71], v156, v[58:59], s[26:27] offset:3072 sc0
    s_mov_b64 exec, -1
    s_waitcnt vmcnt(4)
    v_cndmask_b32 v48, v48, v72, s[56:57]
    v_cndmask_b32 v49, v49, v73, s[56:57]
    v_cndmask_b32 v50, v50, v74, s[58:59]
    v_cndmask_b32 v51, v51, v75, s[58:59]
    v_cndmask_b32 v52, v52, v76, s[60:61]
    v_cndmask_b32 v53, v53, v77, s[60:61]
    v_cndmask_b32 v54, v54, v78, s[62:63]
    v_cndmask_b32 v55, v55, v79, s[62:63]
    v_max_u32 v12, v48, v49
    v_max_u32 v14, v50, v51
    v_max_u32 v15, v52, v53
    v_max_u32 v16, v54, v55
    v_cmp_eq_u32 s[56:57], -1, v12
    v_cmp_eq_u32 s[58:59], -1, v14
    v_cmp_eq_u32 s[60:61], -1, v15
    v_cmp_eq_u32 s[62:63], -1, v16
    s_or_b64 vcc, s[56:57], s[58:59]
    s_or_b64 s[64:65], s[60:61], s[62:63]
    s_or_b64 vcc, vcc, s[64:65]
    s_cbranch_scc0 L_p2d
    s_sub_u32 s3, s3, 1
    s_cbranch_scc0 L_p2l
L_p2d:
    v_lshlrev_b32 v32, 16, v48
    v_and_b32 v33, 0xffff0000, v48
    v_lshlrev_b32 v34, 16, v49
    v_and_b32 v35, 0xffff0000, v49
    v_lshlrev_b32 v36, 16, v50
    v_and_b32 v37, 0xffff0000, v50
    v_lshlrev_b32 v38, 16, v51
    v_and_b32 v39, 0xffff0000, v51
    v_lshlrev_b32 v40, 16, v52
    v_and_b32 v41, 0xffff0000, v52
    v_lshlrev_b32 v42, 16, v53
    v_and_b32 v43, 0xffff0000, v53
    v_lshlrev_b32 v44, 16, v54
    v_and_b32 v45, 0xffff0000, v54
    v_lshlrev_b32 v46, 16, v55
    v_and_b32 v47, 0xffff0000, v55
    v_pk_add_f32 v[32:33], v[32:33], v[36:37]
    v_pk_add_f32 v[34:35], v[34:35], v[38:39]
    v_pk_add_f32 v[40:41], v[40:41], v[44:45]
    v_pk_add_f32 v[42:43], v[42:43], v[46:47]
    v_pk_add_f32 v[32:33], v[32:33], v[40:41]
    v_pk_add_f32 v[34:35], v[34:35], v[42:43]
    s_nop 1
    v_permlane32_swap_b32 v32, v34
    v_permlane32_swap_b32 v33, v35
    v_add_f32 v32, v32, v34
    v_add_f32 v33, v33, v35
    v_cvt_pk_bf16_f32 v34, v32, v33
    v_lshlrev_b32 v32, 16, v34
    v_and_b32 v33, 0xffff0000, v34
    v_add_f32 v32, v32, v24
    v_add_f32 v33, v33, v25
    v_cvt_pk_bf16_f32 v34, v32, v33
    ds_write_b16 v158, v34
    ds_write_b16_d16_hi v158, v34 offset:64
    v_lshlrev_b32 v24, 16, v34
    v_and_b32 v25, 0xffff0000, v34
L_h2_done:
    s_waitcnt lgkmcnt(0)
    s_barrier
    s_cmp_eq_u32 s32, 7
    s_cbranch_scc1 L_stats
    ds_read_b128 v[112:115], v150
    ds_read_b128 v[116:119], v151
    ds_read_b128 v[120:123], v152
    ds_read_b128 v[124:127], v153
    s_waitcnt lgkmcnt(3)
    v_mfma_f32_16x16x32_bf16 v[20:23], v[112:115], v[96:99], 0
    s_waitcnt lgkmcnt(2)
    v_mfma_f32_16x16x32_bf16 v[20:23], v[116:119], v[100:103], v[20:23]
    s_waitcnt lgkmcnt(1)
    v_mfma_f32_16x16x32_bf16 v[20:23], v[120:123], v[104:107], v[20:23]
    s_waitcnt lgkmcnt(0)
    v_mfma_f32_16x16x32_bf16 v[20:23], v[124:127], v[108:111], v[20:23]
    s_nop 7
    v_min_u32 v20, -2, v20
    v_min_u32 v21, -2, v21
    v_min_u32 v22, -2, v22
    v_min_u32 v23, -2, v23
    s_cmp_lg_u32 s35, 0
    s_cbranch_scc1 L_wt_52
    global_store_dwordx4 v144, v[20:23], s[26:27]
L_st_53:
    s_cmp_ge_u32 s32, 2
    s_cbranch_scc1 L_fin
    s_cmp_ge_u32 s31, 14
    s_cbranch_scc1 L_fin
    s_mov_b32 s3, 200000
    global_load_dwordx4 v[32:35], v162, s[26:27] offset:0 sc1
    global_load_dwordx4 v[36:39], v162, s[26:27] offset:1024 sc1
    global_load_dwordx4 v[40:43], v162, s[26:27] offset:2048 sc1
    global_load_dwordx4 v[44:47], v162, s[26:27] offset:3072 sc1
    global_load_dword v52, v164, s[26:27] sc1
    global_load_dword v53, v165, s[26:27] offset:64 sc1
    global_load_dword v48, v163, s[26:27] offset:0 sc1
    global_load_dword v49, v163, s[26:27] offset:256 sc1
    global_load_dword v50, v163, s[26:27] offset:512 sc1
    global_load_dword v51, v163, s[26:27] offset:768 sc1
    s_waitcnt vmcnt(0)
    s_branch L_chk_h3_56
L_poll_h3_54:
    s_mov_b64 exec, s[56:57]
    s_cbranch_execz L_sk_h3_57
    global_load_dwordx4 v[32:35], v162, s[26:27] offset:0 sc1
L_sk_h3_57:
    s_mov_b64 exec, s[58:59]
    s_cbranch_execz L_sk_h3_58
    global_load_dwordx4 v[36:39], v162, s[26:27] offset:1024 sc1
L_sk_h3_58:
    s_mov_b64 exec, s[60:61]
    s_cbranch_execz L_sk_h3_59
    global_load_dwordx4 v[40:43], v162, s[26:27] offset:2048 sc1
L_sk_h3_59:
    s_mov_b64 exec, s[62:63]
    s_cbranch_execz L_sk_h3_60
    global_load_dwordx4 v[44:47], v162, s[26:27] offset:3072 sc1
L_sk_h3_60:
    s_mov_b64 exec, s[64:65]
    s_cbranch_execz L_sk_h3_61
    global_load_dword v52, v164, s[26:27] sc1
    global_load_dword v53, v165, s[26:27] offset:64 sc1
L_sk_h3_61:
    s_mov_b64 exec, s[66:67]
    s_cbranch_execz L_sk_h3_62
    global_load_dword v48, v163, s[26:27] offset:0 sc1
    global_load_dword v49, v163, s[26:27] offset:256 sc1
    global_load_dword v50, v163, s[26:27] offset:512 sc1
    global_load_dword v51, v163, s[26:27] offset:768 sc1
L_sk_h3_62:
    s_mov_b64 exec, -1
    s_waitcnt vmcnt(0)
L_chk_h3_56:
    v_max_u32 v12, v32, v33
    v_max3_u32 v12, v12, v34, v35
    v_cmp_eq_u32 s[56:57], -1, v12
    v_max_u32 v14, v36, v37
    v_max3_u32 v14, v14, v38, v39
    v_cmp_eq_u32 s[58:59], -1, v14
    v_max_u32 v15, v40, v41
    v_max3_u32 v15, v15, v42, v43
    v_cmp_eq_u32 s[60:61], -1, v15
    v_max_u32 v16, v44, v45
    v_max3_u32 v16, v16, v46, v47
    v_cmp_eq_u32 s[62:63], -1, v16
    v_max_u32 v17, v52, v53
    v_cmp_eq_u32 s[64:65], -1, v17
    v_max_u32 v18, v48, v49
    v_max3_u32 v18, v18, v50, v51
    v_cmp_eq_u32 s[66:67], -1, v18
    s_or_b64 vcc, s[56:57], s[58:59]
    s_or_b64 vcc, vcc, s[60:61]
    s_or_b64 vcc, vcc, s[62:63]
    s_or_b64 vcc, vcc, s[64:65]
    s_or_b64 vcc, vcc, s[66:67]
    s_cbranch_scc0 L_done_h3_55
    s_sub_u32 s3, s3, 1
    s_cbranch_scc0 L_poll_h3_54
L_done_h3_55:
    v_add_f32 v48, v48, v49
    v_add_f32 v50, v50, v51
    v_add_f32_dpp v52, v52, v52 quad_perm:[1,0,3,2] row_mask:0xf bank_mask:0xf
    v_add_f32_dpp v53, v53, v53 quad_perm:[1,0,3,2] row_mask:0xf bank_mask:0xf
    s_nop 0
    v_add_f32_dpp v52, v52, v52 quad_perm:[2,3,0,1] row_mask:0xf bank_mask:0xf
    v_add_f32_dpp v53, v53, v53 quad_perm:[2,3,0,1] row_mask:0xf bank_mask:0xf
    s_nop 0
    v_add_f32_dpp v52, v52, v52 row_half_mirror row_mask:0xf bank_mask:0xf
    v_add_f32_dpp v53, v53, v53 row_half_mirror row_mask:0xf bank_mask:0xf
    s_nop 0
    v_add_f32_dpp v52, v52, v52 row_mirror row_mask:0xf bank_mask:0xf
    v_add_f32_dpp v53, v53, v53 row_mirror row_mask:0xf bank_mask:0xf
    v_add_f32 v48, v48, v50
    v_pk_add_f32 v[32:33], v[32:33], v[36:37]
    v_pk_add_f32 v[34:35], v[34:35], v[38:39]
    v_pk_add_f32 v[40:41], v[40:41], v[44:45]
    v_pk_add_f32 v[42:43], v[42:43], v[46:47]
    v_pk_add_f32 v[32:33], v[32:33], v[40:41]
    v_pk_add_f32 v[34:35], v[34:35], v[42:43]
    v_mov_b32 v49, v48
    s_nop 1
    v_permlane16_swap_b32 v48, v49
    v_add_f32 v48, v48, v49
    v_mov_b32 v49, v48
    s_nop 1
    v_permlane32_swap_b32 v48, v49
    v_add_f32 v48, v48, v49
    v_mul_f32 v25, 0x3b000000, v53
    v_mul_f32 v24, 0x3b000000, v52
    v_permlane32_swap_b32 v32, v34
    v_permlane32_swap_b32 v33, v35
    v_add_f32 v32, v32, v34
    v_add_f32 v33, v33, v35
    s_nop 1
    v_permlane16_swap_b32 v32, v33
    v_add_f32 v32, v32, v33
    v_fma_f32 v24, -v25, v25, v24
    v_max_f32 v24, 0, v24
    v_cvt_pk_bf16_f32 v25, v25, v25
    v_and_b32 v25, 0xffff0000, v25
    v_cvt_pk_bf16_f32 v24, v24, v24
    v_and_b32 v24, 0xffff0000, v24
    v_add_f32 v24, 0x3727c5ac, v24
    v_cvt_pk_bf16_f32 v24, v24, v24
    v_and_b32 v24, 0xffff0000, v24
    v_sqrt_f32 v24, v24
    v_fma_f32 v32, -v25, v48, v32
    v_cvt_pk_bf16_f32 v24, v24, v24
    v_and_b32 v24, 0xffff0000, v24
    v_rcp_f32 v24, v24
    s_nop 0
    v_mul_f32 v32, v32, v24
    v_cvt_pk_bf16_f32 v32, v32, v32
    v_and_b32 v32, 0xffff0000, v32
    v_mul_f32 v34, s41, v32
    v_exp_f32 v34, v34
    v_mov_b32_dpp v33, v32 row_ror:8 row_mask:0xf bank_mask:0xf
    v_add_f32 v34, 1.0, v34
    v_rcp_f32 v34, v34
    s_nop 0
    v_cvt_pk_bf16_f32 v34, v34, v34
    v_and_b32 v34, 0xffff0000, v34
    v_mul_f32 v34, v34, v33
    s_nop 1
    v_mov_b32_dpp v35, v34 quad_perm:[1,1,3,3] row_mask:0xf bank_mask:0xf
    v_cvt_pk_bf16_f32 v34, v34, v35
    v_min_u32 v34, -2, v34
    s_mov_b64 exec, s[44:45]
    s_cmp_lg_u32 s35, 0
    s_cbranch_scc1 L_wt_63
    global_store_dword v166, v34, s[26:27]
L_st_64:
    s_mov_b64 exec, -1
    s_branch L_fin
L_stats:
    ds_read_b128 v[112:115], v154
    s_waitcnt lgkmcnt(0)
    v_mfma_f32_16x16x32_bf16 v[20:23], v[112:115], v[112:115], 0
    s_nop 7
    v_min_u32 v20, -2, v20
    v_min_u32 v21, -2, v21
    v_min_u32 v22, -2, v22
    v_min_u32 v23, -2, v23
    s_mov_b64 exec, 0x000f000f
    s_cmp_lg_u32 s35, 0
    s_cbranch_scc1 L_wt_65
    global_store_dwordx4 v146, v[20:23], s[26:27]
L_st_66:
    s_mov_b64 exec, -1
    s_xor_b32 s43, s28, s31
    s_bitcmp1_b32 s43, 0
    s_cbranch_scc1 L_fin
    ds_read_b32 v26, v160
    s_waitcnt lgkmcnt(0)
    v_lshlrev_b32 v24, 16, v26
    v_and_b32 v25, 0xffff0000, v26
    s_barrier
    s_mov_b32 s3, 200000
    global_atomic_add_x2 v[32:33], v155, v[58:59], s[26:27] offset:0 sc0
    global_atomic_add_x2 v[34:35], v155, v[58:59], s[26:27] offset:2048 sc0
    s_waitcnt vmcnt(0)
    s_branch L_chk_h5_69
L_poll_h5_67:
    s_mov_b64 exec, s[56:57]
    s_cbranch_execz L_sk_h5_70
    global_atomic_add_x2 v[32:33], v155, v[58:59], s[26:27] offset:0 sc0
L_sk_h5_70:
    s_mov_b64 exec, s[58:59]
    s_cbranch_execz L_sk_h5_71
    global_atomic_add_x2 v[34:35], v155, v[58:59], s[26:27] offset:2048 sc0
L_sk_h5_71:
    s_mov_b64 exec, -1
    s_waitcnt vmcnt(0)
L_chk_h5_69:
    v_max_u32 v12, v32, v33
    v_cmp_eq_u32 s[56:57], -1, v12
    v_max_u32 v14, v34, v35
    v_cmp_eq_u32 s[58:59], -1, v14
    s_nop 0
    s_or_b64 vcc, s[56:57], s[58:59]
    s_cbranch_scc0 L_done_h5_68
    s_sub_u32 s3, s3, 1
    s_cbranch_scc0 L_poll_h5_67
L_done_h5_68:
    v_pk_add_f32 v[40:41], v[32:33], v[34:35]
    v_mov_b32 v42, v40
    v_mov_b32 v43, v41
    s_nop 0
    v_permlane16_swap_b32 v40, v42
    v_permlane16_swap_b32 v41, v43
    v_add_f32 v40, v40, v42
    v_add_f32 v41, v41, v43
    v_mov_b32 v42, v40
    v_mov_b32 v43, v41
    s_nop 0
    v_permlane32_swap_b32 v40, v42
    v_permlane32_swap_b32 v41, v43
    v_add_f32 v40, v40, v42
    v_add_f32 v41, v41, v43
    v_cvt_pk_bf16_f32 v42, v40, v41
    v_lshlrev_b32 v40, 16, v42
    v_and_b32 v41, 0xffff0000, v42
    v_pk_add_f32 v[40:41], v[40:41], v[24:25]
    v_cvt_pk_bf16_f32 v42, v40, v41
    s_mov_b64 exec, 0xffff
    global_store_dword v143, v42, s[22:23]
    s_mov_b64 exec, -1
    s_or_b32 s43, s31, s28
    s_cmp_lg_u32 s43, 0
    s_cbranch_scc1 L_fin
    s_add_u32 s43, s34, 1
    v_mov_b32 v14, 0
    v_mov_b32 v15, s43
    s_mov_b64 exec, 1
    global_store_dword v14, v15, s[26:27]
    s_mov_b64 exec, -1
L_fin:
L_end:
    s_endpgm
L_wt_11:
    global_store_dwordx4 v20, v[40:43], s[26:27] sc1
    global_store_dwordx4 v44, v[40:43], s[26:27] sc1
    global_store_dwordx4 v45, v[40:43], s[26:27] sc1
    global_store_dwordx4 v46, v[40:43], s[26:27] sc1
    global_store_dwordx4 v47, v[40:43], s[26:27] sc1
    global_store_dwordx4 v48, v[40:43], s[26:27] sc1
    global_store_dwordx4 v49, v[40:43], s[26:27] sc1
    global_store_dwordx4 v21, v[40:43], s[26:27] sc1
    global_store_dwordx4 v22, v[40:43], s[26:27] sc1
    s_nop 1
    s_branch L_st_12
L_wt_15:
    global_store_dwordx2 v14, v[28:29], s[26:27] sc1
    s_nop 1
    s_branch L_st_16
L_wt_27:
    global_store_dwordx2 v10, v[24:25], s[26:27] sc1
    s_nop 1
    s_branch L_st_28
L_wt_48:
    global_store_dwordx2 v10, v[24:25], s[26:27] sc1
    s_nop 1
    s_branch L_st_49
L_wt_50:
    global_store_dword v145, v20, s[26:27] sc1
    s_nop 1
    s_branch L_st_51
L_wt_52:
    global_store_dwordx4 v144, v[20:23], s[26:27] sc1
    s_nop 1
    s_branch L_st_53
L_wt_63:
    global_store_dword v166, v34, s[26:27] sc1
    s_nop 1
    s_branch L_st_64
L_wt_65:
    global_store_dwordx4 v146, v[20:23], s[26:27] sc1
    s_nop 1
    s_branch L_st_66
    s_endpgm
    .fill 1024, 4, 0xbf810000
.section .rodata,"a"
.p2align 6
.amdhsa_kernel sequential_preLN__sliding_block_cached__glu_gated_glu__decode_kernel
  .amdhsa_next_free_vgpr 168
  .amdhsa_next_free_sgpr 102
  .amdhsa_accum_offset 168
  .amdhsa_group_segment_fixed_size 0
  .amdhsa_kernarg_size 96
  .amdhsa_user_sgpr_count 2
  .amdhsa_user_sgpr_kernarg_segment_ptr 1
  .amdhsa_system_sgpr_workgroup_id_x 1
.end_amdhsa_kernel
```
